```python
import torch

def _softmax(x, axis=-1):
    return torch.softmax(x, dim=axis)
def _gelu(x):
    return torch.nn.functional.gelu(x, approximate="tanh")
def _silu(x):
    return torch.nn.functional.silu(x)
def _sigmoid(x):
    return torch.sigmoid(x)
def _layernorm(x, axis=-1, eps=1e-5):
    m = x.mean(dim=axis, keepdim=True)
    v = x.var(dim=axis, keepdim=True, unbiased=False)
    return (x - m) / torch.sqrt(v + eps)
def _scatter_add(tgt, idx, src, axis=0):
    return tgt.clone().index_add_(axis, idx, src)
def _segment_sum(src, seg, n):
    out = torch.zeros((n,) + src.shape[1:], dtype=src.dtype)
    return out.index_add_(0, seg, src)
def _pad(x, pw):
    flat = tuple(v for pair in reversed(pw) for v in pair)
    return torch.nn.functional.pad(x, flat)

kernel_name = 'gated_mix__sliding_block__glu_gated_glu__prompt'

def setup_inputs():

    _w = (lambda a: (lambda t: t.to(torch.bfloat16) if t.is_floating_point() else t)(torch.as_tensor(a)))
    def _A_setup():
        B, S, D = 1, 2048, 448
        return {
            "x": _w((lambda *s: torch.randn(*s, dtype=torch.bfloat16) * 0.05)(B, S, D)),
            "wqkv": _w((lambda *s: torch.randn(*s, dtype=torch.bfloat16) * 1.6)(D, 3 * D)),
            "wo": _w((lambda *s: torch.randn(*s, dtype=torch.bfloat16) * 0.05)(D, D)),
        }
    _A_in = _A_setup()

    def _B_setup():
        B, S, D, F = 1, 2048, 448, 1792
        return {
            "x": _w((lambda *s: torch.randn(*s, dtype=torch.bfloat16) * 0.05)(B, S, D)),
            "w_gate": _w((lambda *s: torch.randn(*s, dtype=torch.bfloat16) * 3.2)(D, F)),
            "w_up": _w((lambda *s: torch.randn(*s, dtype=torch.bfloat16) * 0.2)(D, F)),
            "w_down": _w((lambda *s: torch.randn(*s, dtype=torch.bfloat16) * 0.2)(F, D)),
        }
    _B_in = _B_setup()

    return {
        "A_x": _A_in["x"],
        "A_wqkv": _A_in["wqkv"],
        "A_wo": _A_in["wo"],
        "B_x": _B_in["x"],
        "B_w_gate": _B_in["w_gate"],
        "B_w_up": _B_in["w_up"],
        "B_w_down": _B_in["w_down"],
        "gate_w": _w((lambda *s: torch.randn(*s, dtype=torch.bfloat16) * 0.05)(448) * 16.0),
    }

def reference(A_x, A_wqkv, A_wo, B_x, B_w_gate, B_w_up, B_w_down, gate_w):
    def _A_ref(x, wqkv, wo):
        B, S, D = x.shape
        H = 16; Dh = D // H; W = 256
        qkv = (lambda x, *d: x.permute(*d))((x @ wqkv).reshape(B, S, 3, H, Dh), 2, 0, 3, 1, 4)
        q, k, v = qkv[0], qkv[1], qkv[2]
        scores = torch.einsum("bhqd,bhkd->bhqk", q, k) * (Dh ** -0.5)
        idx = torch.arange(S)
        mask = (idx[:, None] - idx[None, :] >= 0) & (idx[:, None] - idx[None, :] < W)
        scores = torch.where(mask[None, None], scores, -1e9)
        p = _softmax(scores, axis=-1)
        o = torch.einsum("bhqk,bhkd->bhqd", p, v)
        return (lambda x, *d: x.permute(*d))(o, 0, 2, 1, 3).reshape(B, S, D) @ wo

    def _B_ref(x, w_gate, w_up, w_down):
        g = torch.einsum("bsd,df->bsf", x, w_gate)
        u = torch.einsum("bsd,df->bsf", x, w_up)
        h = _sigmoid(g) * u
        return torch.einsum("bsf,fd->bsd", h, w_down)

    x = A_x
    g = _sigmoid((x * gate_w).sum(-1, keepdims=True))
    a = _A_ref(x, A_wqkv, A_wo)
    b = _B_ref(x, B_w_gate, B_w_up, B_w_down)
    return g * a + (1 - g) * b
```

```asm
; @launch grid=(256,1,1) block=(256,1,1) lds=163840
.amdgcn_target "amdgcn-amd-amdhsa--gfx950"
.text
.globl gated_mix__sliding_block__glu_gated_glu__prompt_kernel
.p2align 8
.type gated_mix__sliding_block__glu_gated_glu__prompt_kernel,@function
gated_mix__sliding_block__glu_gated_glu__prompt_kernel:
    s_cmp_ge_u32 s2, 0x100
    s_cbranch_scc1 L_exit
    s_load_dwordx16 s[64:79], s[0:1], 0
    s_load_dwordx4 s[80:83], s[0:1], 64
    s_load_dwordx2 s[24:25], s[0:1], 80
    s_getpc_b64 s[4:5]
L_pc:
    s_lshr_b32 s3, s2, 3
    s_mul_i32 s3, s3, 10
    v_min_u32_e32 v33, 9, v0
    v_add_lshl_u32 v33, v33, s3, 7
    v_min_u32 v33, L_exit-L_pc, v33
    global_load_dword v45, v33, s[4:5]
    v_lshrrev_b32_e32 v35, 6, v0
    v_and_b32_e32 v0, 63, v0
    v_readfirstlane_b32 s44, v35
    s_and_b32 s3, s2, 7
    s_lshr_b32 s6, s2, 3
    s_and_b32 s7, s3, 1
    s_lshl_b32 s7, s7, 3
    s_and_b32 s4, s6, 7
    s_add_u32 s45, s4, s7
    s_lshr_b32 s7, s3, 1
    s_lshl_b32 s7, s7, 2
    s_lshr_b32 s5, s6, 3
    s_add_u32 s95, s5, s7
    s_mov_b32 s86, 0xf543e210
    s_mov_b32 s87, 0xdcba9876
    s_lshl_b32 s7, s95, 2
    s_lshr_b64 s[86:87], s[86:87], s7
    s_and_b32 s46, s86, 15
    v_lshlrev_b32_e32 v1, 4, v0
    v_lshrrev_b32_e32 v35, 3, v0
    v_and_b32_e32 v36, 7, v0
    v_lshrrev_b32_e32 v37, 4, v0
    v_mul_u32_u24 v38, 0x380, v35
    v_xor_b32_e32 v39, v36, v37
    v_lshl_add_u32 v2, v39, 4, v38
    v_xor_b32_e32 v3, 64, v2
    v_add_u32 v3, 6144, v3
    v_add_u32 v4, 12288, v2
    v_add_u32 v5, 12288, v3
    v_and_b32_e32 v39, 2, v35
    v_lshlrev_b32_e32 v39, 1, v39
    v_xor_b32_e32 v39, v36, v39
    v_lshlrev_b32_e32 v39, 4, v39
    s_cmp_ge_u32 s46, 14
    s_cselect_b32 s47, 1, 0
    s_movk_i32 s7, 0xe00
    s_movk_i32 s86, 0xa80
    s_cselect_b32 s7, s86, s7
    v_mul_u32_u24 v40, 0xa80, v35
    v_add_u32_e32 v8, v40, v39
    v_add_u32 v9, 20480, v8
    v_xor_b32_e32 v9, 32, v9
    v_mul_u32_u24_e32 v40, s7, v35
    v_add_u32_e32 v6, v40, v39
    s_lshl_b32 s86, s7, 3
    s_sub_u32 s86, s86, 0x400
    v_add_u32_e32 v7, s86, v6
    v_xor_b32_e32 v7, 32, v7
    s_lshl_b32 s52, s7, 6
    v_lshrrev_b32_e32 v42, 1, v0
    v_and_b32_e32 v43, 1, v0
    v_lshlrev_b32_e32 v44, 7, v43
    v_mul_u32_u24 v41, 0x380, v43
    v_lshl_add_u32 v41, v42, 7, v41
    v_mul_u32_u24_e32 v46, s52, v42
    v_add_u32_e32 v46, v46, v44
    v_mul_u32_u24 v47, 172032, v42
    v_add_u32_e32 v47, v47, v44
    s_lshl_b32 s86, s45, 2
    s_add_u32 s87, s86, s44
    s_mul_i32 s48, s87, 28672
    s_mul_i32 s3, s87, s7
    s_mul_i32 s4, s87, 0xa80
    s_lshl_b32 s86, s45, 4
    s_add_u32 s86, s86, s46
    s_lshl_b32 s86, s86, 2
    s_add_u32 s86, s86, s44
    s_mul_i32 s6, s86, 1792
    s_mul_i32 s5, s86, 49
    s_lshl_b32 s86, s44, 4
    s_mul_i32 s87, s86, s7
    s_mul_i32 s88, s86, 0xa80
    s_lshl_b32 s89, s46, 8
    s_lshl_b32 s90, s46, 7
    s_lshl_b32 s91, s46, 9
    s_sub_u32 s91, s91, 5376
    s_add_u32 s92, s91, 0x80
    s_add_u32 s93, s91, 0x100
    s_add_u32 s94, s89, 0x80
    s_cmp_lg_u32 s47, 0
    s_cselect_b32 s91, s91, s89
    s_cselect_b32 s92, s92, s89
    s_cselect_b32 s93, s93, s90
    s_cselect_b32 s90, 2176, s94
    s_add_u32 s49, s91, s87
    s_add_u32 s50, s92, s87
    s_add_u32 s51, s93, s88
    s_add_u32 s55, s90, s87
    s_add_u32 s56, s94, s87
    s_mul_i32 s53, s44, 10240
    s_add_u32 s86, s91, s3
    s_add_u32 s87, s92, s3
    s_add_u32 s88, s93, s4
    v_add_u32_e32 v200, s6, v41
    v_add_u32_e32 v201, s86, v46
    v_add_u32_e32 v202, s87, v46
    v_add_u32_e32 v203, s88, v47
    s_mov_b32 s10, 1835008
    s_mov_b32 s11, 0x20000
    s_mov_b32 s22, 1204224
    s_cmp_lg_u32 s47, 0
    s_cselect_b32 s14, s22, 1605632
    s_mov_b32 s18, s14
    s_mov_b32 s15, s11
    s_mov_b32 s19, s11
    s_mov_b32 s23, s11
    s_waitcnt lgkmcnt(0)
    s_mov_b32 s8, s64
    s_mov_b32 s9, s65
    s_cselect_b32 s12, s66, s72
    s_cselect_b32 s13, s67, s73
    s_cselect_b32 s16, s66, s74
    s_cselect_b32 s17, s67, s75
    s_mov_b32 s20, s66
    s_mov_b32 s21, s67
    s_mov_b64 exec, 0x3f
    buffer_load_dword v45, v200, s[8:11], 0 offen
    s_mov_b64 exec, 0x15
    buffer_load_dword v45, v201, s[12:15], 0 offen
    buffer_load_dword v45, v202, s[16:19], 0 offen
    buffer_load_dword v45, v203, s[20:23], 0 offen
    s_mov_b64 exec, -1
    s_add_u32 m0, s53, 0
    s_nop 0
    buffer_load_dwordx4 v2, s[8:11], s48 offen offset:0 lds
    buffer_load_dwordx4 v3, s[8:11], s48 offen offset:1024 lds
    buffer_load_dwordx4 v4, s[8:11], s48 offen offset:2048 lds
    buffer_load_dwordx4 v5, s[8:11], s48 offen offset:3072 lds
    s_add_u32 m0, s53, 4096
    s_add_u32 s48, s48, 0x80
    buffer_load_dwordx4 v6, s[12:15], s49 offen offset:0 lds
    buffer_load_dwordx4 v7, s[12:15], s49 offen offset:1024 lds
    s_add_u32 m0, s53, 6144
    s_add_u32 s49, s49, s52
    buffer_load_dwordx4 v6, s[16:19], s50 offen offset:0 lds
    buffer_load_dwordx4 v7, s[16:19], s50 offen offset:1024 lds
    s_add_u32 m0, s53, 8192
    s_add_u32 s50, s50, s52
    buffer_load_dwordx4 v8, s[20:23], s51 offen offset:0 lds
    buffer_load_dwordx4 v9, s[20:23], s51 offen offset:1024 lds
    s_add_u32 s51, s51, 172032
    s_lshl_b32 s54, s44, 12
    s_mov_b32 s28, s76
    s_mov_b32 s29, s77
    s_mov_b32 s30, 1605632
    s_mov_b32 s31, 0x20000
    s_mov_b32 s32, s68
    s_mov_b32 s33, s69
    s_mov_b32 s34, 401408
    s_mov_b32 s35, 0x20000
    s_lshr_b32 s86, s5, 2
    s_lshl_b32 s86, s86, 7
    s_lshr_b32 s5, s5, 4
    s_lshl_b32 s5, s5, 7
    v_lshlrev_b32_e32 v44, 7, v0
    v_add_u32_e64 v204, s86, v44
    v_add_u32_e64 v205, s5, v44
    s_mov_b32 s26, 16777216
    s_mov_b32 s27, 0x20000
    v_mov_b32_e64 v49, 0
    s_mov_b32 s86, 15859712
    buffer_load_dword v48, v49, s[24:27], s86 offen sc1
    s_mov_b32 s36, s80
    s_mov_b32 s37, s81
    s_mov_b32 s38, 1835008
    s_mov_b32 s39, 0x20000
    s_mov_b64 s[40:41], s[82:83]
    s_mov_b64 s[42:43], s[78:79]
    s_lshr_b32 s86, s44, 1
    s_and_b32 s87, s44, 1
    v_and_b32_e64 v35, 15, v0
    v_lshrrev_b32_e64 v36, 4, v0
    v_bfe_u32 v37, v0, 1, 3
    v_xor_b32_e64 v37, v37, v36
    s_mul_i32 s88, s86, 20480
    v_lshlrev_b32_e64 v38, 7, v35
    v_add_u32_e64 v38, s88, v38
    v_lshl_add_u32 v12, v37, 4, v38
    v_xor_b32_e64 v13, 64, v12
    v_lshlrev_b32_e64 v10, 4, v35
    v_lshl_add_u32 v10, v36, 9, v10
    v_add_u32 v11, 0x1000, v10
    v_bfe_u32 v37, v0, 2, 2
    v_and_b32_e64 v39, 1, v36
    v_lshl_add_u32 v38, v39, 3, v37
    v_lshlrev_b32_e64 v38, 7, v38
    v_and_b32_e64 v40, 3, v0
    v_lshl_add_u32 v38, v40, 3, v38
    v_and_b32_e64 v40, 2, v37
    v_xor_b32_e64 v40, v40, v39
    s_lshl_b32 s88, s87, 1
    v_xor_b32_e32 v40, s88, v40
    v_lshl_add_u32 v38, v40, 5, v38
    v_lshrrev_b32_e64 v39, 5, v0
    v_mul_u32_u24 v40, 10240, v39
    v_add_u32_e64 v18, v40, v38
    v_xor_b32_e64 v19, 32, v18
    v_lshl_add_u32 v24, v39, 12, v38
    v_xor_b32_e64 v25, 32, v24
    v_add_u32 v14, 65536, v12
    v_add_u32 v15, 65536, v13
    v_add_u32 v20, 65536, v18
    v_add_u32 v21, 65536, v19
    v_add_u32 v26, 65536, v24
    v_add_u32 v27, 65536, v25
    v_add_u32 v16, 131072, v12
    v_add_u32 v17, 131072, v13
    v_add_u32 v22, 131072, v18
    v_add_u32 v23, 131072, v19
    v_add_u32 v28, 131072, v24
    v_add_u32 v29, 131072, v25
    s_lshl_b32 s88, s45, 2
    s_lshl_b32 s89, s86, 1
    s_add_u32 s88, s88, s89
    s_mul_i32 s89, s88, 86016
    s_lshl_b32 s90, s87, 11
    s_add_u32 s89, s89, s90
    s_lshl_b32 s90, s46, 12
    s_lshl_b32 s91, s46, 14
    s_sub_u32 s91, s91, 163840
    s_cmp_lg_u32 s47, 0
    s_cselect_b32 s90, s91, s90
    s_add_u32 s58, s89, s90
    s_add_u32 s59, s58, 86016
    s_mul_i32 s89, s88, 147456
    s_lshl_b32 s90, s46, 13
    s_lshl_b32 s91, s87, 11
    s_add_u32 s89, s89, s90
    s_add_u32 s89, s89, s91
    s_add_u32 s60, s89, 6291456
    s_add_u32 s61, s60, 147456
    s_mov_b32 s62, 0xbfb8aa3b
    s_mov_b32 s63, 0x3e8b97f6
    s_lshl_b32 s88, s45, 13
    s_lshl_b32 s89, s46, 9
    s_add_u32 s88, s88, s89
    s_add_u32 s88, s88, 16252928
    v_lshl_add_u32 v50, v0, 2, s88
    v_lshrrev_b32_e32 v51, 4, v0
    v_add_u32_e64 v51, s45, v51
    v_subrev_u32_e64 v51, 2, v51
    v_max_i32_e64 v51, 0, v51
    v_min_u32_e64 v51, 15, v51
    v_lshlrev_b32_e64 v51, 13, v51
    v_and_b32_e64 v33, 15, v0
    v_lshl_add_u32 v51, v33, 9, v51
    v_add_u32 v51, 16252928, v51
    s_mul_i32 s86, s95, 28
    s_add_u32 s87, s86, 27
    s_lshr_b32 s86, s86, 6
    s_lshr_b32 s87, s87, 6
    s_lshl_b32 s88, 1, s86
    s_lshl_b32 s89, 1, s87
    s_or_b32 s88, s88, s89
    s_lshl_b32 s89, s88, 7
    s_mul_i32 s64, s89, 0x10001
    s_or_b32 s65, s88, s89
    s_cmp_le_u32 s86, 3
    s_cselect_b32 s90, 0x4000, 0
    s_cmp_ge_u32 s87, 3
    s_cselect_b32 s91, 0x8000, 0
    s_or_b32 s90, s90, s91
    s_mul_i32 s66, s90, 0x10001
    s_mov_b32 s67, s90
    s_and_b32 s86, s95, 1
    s_sub_u32 s68, 0, s86
    s_mov_b32 s69, s68
    s_mul_i32 s87, s95, 7
    s_lshr_b32 s87, s87, 1
    s_lshl_b32 s87, s87, 9
    s_lshl_b32 s88, s45, 2
    s_mul_i32 s89, s44, 3
    s_add_u32 s89, s89, s88
    s_sub_u32 s89, s89, 8
    s_add_u32 s90, s89, 0
    s_max_i32 s90, s90, 0
    s_mul_i32 s90, s90, 86016
    s_add_u32 s90, s90, s87
    s_add_u32 s70, s90, 28672
    s_add_u32 s90, s89, 1
    s_max_i32 s90, s90, 0
    s_mul_i32 s90, s90, 86016
    s_add_u32 s90, s90, s87
    s_add_u32 s71, s90, 28672
    s_add_u32 s90, s89, 2
    s_max_i32 s90, s90, 0
    s_mul_i32 s90, s90, 86016
    s_add_u32 s90, s90, s87
    s_add_u32 s72, s90, 28672
    v_lshrrev_b32_e64 v33, 5, v0
    v_add_u32_e64 v34, s89, v33
    v_mov_b32 v35, 0xf149
    v_cmp_gt_i32 vcc, 0, v34
    s_nop 1
    v_cndmask_b32 v220, 0, v35, vcc
    v_mov_b32_e32 v221, 0
    s_add_u32 s90, s89, 2
    s_cmp_lt_i32 s90, 0
    s_cselect_b32 s90, 0xf149, 0
    v_mov_b32_e64 v222, s90
    v_mov_b32_e64 v223, 0
    v_mov_b32 v224, 0x3f80
    v_mov_b32_e64 v225, 0
    s_cmp_eq_u32 s86, 0
    s_cselect_b32 s90, 1544, 0
    s_mul_i32 s91, s44, 6144
    s_add_u32 s90, s90, s91
    s_add_u32 s90, s90, 0
    v_and_b32_e32 v34, 31, v0
    v_lshlrev_b32_e64 v34, 4, v34
    v_add_u32_e64 v227, s90, v34
    v_lshl_add_u32 v226, v33, 11, v227
    v_and_b32_e64 v34, 31, v0
    v_lshlrev_b32_e64 v35, 2, v33
    v_xor_b32_e64 v34, v34, v35
    v_lshlrev_b32_e64 v34, 4, v34
    v_lshl_add_u32 v228, v33, 9, v34
    v_xor_b32 v229, 0x80, v228
    s_lshl_b32 s90, s44, 11
    s_add_u32 s91, s90, 0
    v_add_u32_e64 v236, s91, v1
    v_bfe_u32 v34, v0, 4, 1
    v_bfe_u32 v35, v0, 1, 1
    v_lshl_add_u32 v34, v34, 1, v35
    v_xor_b32_e64 v35, v33, v34
    v_lshlrev_b32_e64 v35, 2, v35
    v_bfe_u32 v36, v0, 2, 2
    v_add_u32_e64 v35, v35, v36
    v_lshlrev_b32_e64 v35, 4, v35
    v_lshl_add_u32 v35, v34, 9, v35
    v_and_b32_e64 v36, 1, v0
    v_lshl_add_u32 v35, v36, 3, v35
    s_add_u32 s91, s90, 24576
    v_add_u32_e64 v237, s91, v35
    v_xor_b32 v238, 0x80, v237
    v_subrev_u32_e64 v34, 1, v33
    v_and_b32_e64 v34, s68, v34
    v_not_b32_e64 v30, v34
    v_sub_u32_e64 v34, 0, v33
    s_not_b32 s91, s68
    v_and_b32_e32 v34, s91, v34
    v_not_b32_e64 v32, v34
    s_add_u32 s88, s88, s44
    s_mul_i32 s90, s88, 86016
    s_add_u32 s73, s90, s87
    s_mul_i32 s90, s88, 147456
    s_lshl_b32 s91, s95, 11
    s_add_u32 s90, s90, s91
    s_add_u32 s75, s90, 6406144
    s_lshl_b32 s90, s88, 7
    s_add_u32 s74, s90, 15728640
    v_lshlrev_b32_e32 v240, 2, v33
    v_and_b32_e64 v241, 31, v0
    v_sub_u32_e64 v240, v241, v240
    v_mov_b32 v241, 4048155338
    s_add_u32 m0, s53, 40960
    s_nop 0
    buffer_load_dwordx4 v2, s[8:11], s48 offen offset:0 lds
    buffer_load_dwordx4 v3, s[8:11], s48 offen offset:1024 lds
    buffer_load_dwordx4 v4, s[8:11], s48 offen offset:2048 lds
    buffer_load_dwordx4 v5, s[8:11], s48 offen offset:3072 lds
    s_add_u32 m0, s53, 45056
    s_add_u32 s48, s48, 0x80
    buffer_load_dwordx4 v6, s[12:15], s49 offen offset:0 lds
    buffer_load_dwordx4 v7, s[12:15], s49 offen offset:1024 lds
    s_add_u32 m0, s53, 47104
    s_add_u32 s49, s49, s52
    buffer_load_dwordx4 v6, s[16:19], s50 offen offset:0 lds
    buffer_load_dwordx4 v7, s[16:19], s50 offen offset:1024 lds
    s_add_u32 m0, s53, 49152
    s_add_u32 s50, s50, s52
    buffer_load_dwordx4 v8, s[20:23], s51 offen offset:0 lds
    buffer_load_dwordx4 v9, s[20:23], s51 offen offset:1024 lds
    s_add_u32 s51, s51, 172032
    s_cmp_eq_u32 s44, 0
    s_cbranch_scc0 L_nofc1
    v_lshl_add_u32 v33, v0, 2, v50
    v_mov_b32_e32 v34, 0
    v_mov_b32_e64 v35, 0
    buffer_store_dwordx2 v[34:35], v33, s[24:27], 0 offen sc1
L_nofc1:
    s_waitcnt vmcnt(11)
    s_or_b32 s86, s2, s44
    s_cmp_eq_u32 s86, 0
    s_cbranch_scc0 L_notag
    s_waitcnt vmcnt(10)
    v_add_u32_e32 v34, 2, v48
    v_or_b32_e64 v34, 1, v34
    s_mov_b32 s86, 15859712
    s_mov_b64 exec, 1
    buffer_store_dword v34, v49, s[24:27], s86 offen sc1
    global_store_dword v49, v34, s[40:41] sc1
    s_mov_b64 exec, -1
L_notag:
    s_barrier
    ds_read_b64_tr_b16 a[224:225], v18 offset:8192
    ds_read_b64_tr_b16 a[226:227], v18 offset:8704
    ds_read_b128 a[0:3], v12 offset:0
    ds_read_b128 a[4:7], v12 offset:2048
    ds_read_b128 a[8:11], v12 offset:10240
    ds_read_b128 a[12:15], v12 offset:12288
    ds_read_b64_tr_b16 a[228:229], v19 offset:8192
    ds_read_b64_tr_b16 a[230:231], v19 offset:8704
    ds_read_b64_tr_b16 a[232:233], v18 offset:4096
    ds_read_b64_tr_b16 a[234:235], v18 offset:4608
    ds_read_b64_tr_b16 a[236:237], v19 offset:4096
    ds_read_b64_tr_b16 a[238:239], v19 offset:4608
    ds_read_b64_tr_b16 a[240:241], v18 offset:6144
    ds_read_b64_tr_b16 a[242:243], v18 offset:6656
    s_waitcnt lgkmcnt(11)
    v_mfma_f32_16x16x32_bf16 v[52:55], a[224:227], a[0:3], 0
    ds_read_b64_tr_b16 a[244:245], v19 offset:6144
    s_add_u32 m0, s53, 81920
    s_waitcnt lgkmcnt(11)
    v_mfma_f32_16x16x32_bf16 v[60:63], a[224:227], a[4:7], 0
    ds_read_b64_tr_b16 a[246:247], v19 offset:6656
    buffer_load_dwordx4 v2, s[8:11], s48 offen offset:0 lds
    s_waitcnt lgkmcnt(11)
    v_mfma_f32_16x16x32_bf16 v[68:71], a[224:227], a[8:11], 0
    s_mov_b64 exec, 0x3fc0
    buffer_load_dword v45, v200, s[8:11], 0 offen
    s_mov_b64 exec, 0x1540
    buffer_load_dword v45, v201, s[12:15], 0 offen
    buffer_load_dword v45, v202, s[16:19], 0 offen
    buffer_load_dword v45, v203, s[20:23], 0 offen
    s_mov_b64 exec, -1
    s_waitcnt lgkmcnt(10)
    v_mfma_f32_16x16x32_bf16 v[76:79], a[224:227], a[12:15], 0
    buffer_load_dwordx4 v3, s[8:11], s48 offen offset:1024 lds
    s_waitcnt lgkmcnt(8)
    v_mfma_f32_16x16x32_bf16 v[80:83], a[228:231], a[12:15], 0
    ds_read_b64_tr_b16 a[248:249], v18 offset:28672
    buffer_load_dwordx4 v4, s[8:11], s48 offen offset:2048 lds
    v_mfma_f32_16x16x32_bf16 v[72:75], a[228:231], a[8:11], 0
    ds_read_b64_tr_b16 a[250:251], v18 offset:29184
    buffer_load_dwordx4 v5, s[8:11], s48 offen offset:3072 lds
    v_mfma_f32_16x16x32_bf16 v[64:67], a[228:231], a[4:7], 0
    ds_read_b128 a[16:19], v13 offset:0
    v_mfma_f32_16x16x32_bf16 v[56:59], a[228:231], a[0:3], 0
    ds_read_b128 a[20:23], v13 offset:2048
    s_waitcnt lgkmcnt(10)
    v_mfma_f32_16x16x32_bf16 v[84:87], a[232:235], a[0:3], 0
    ds_read_b64_tr_b16 a[252:253], v19 offset:28672
    s_add_u32 m0, s53, 86016
    v_mfma_f32_16x16x32_bf16 v[100:103], a[232:235], a[4:7], 0
    ds_read_b64_tr_b16 a[254:255], v19 offset:29184
    v_mfma_f32_16x16x32_bf16 v[116:119], a[232:235], a[8:11], 0
    ds_read_b128 a[24:27], v13 offset:10240
    s_add_u32 s48, s48, 0x80
    v_mfma_f32_16x16x32_bf16 v[132:135], a[232:235], a[12:15], 0
    ds_read_b128 a[28:31], v13 offset:12288
    s_waitcnt lgkmcnt(12)
    v_mfma_f32_16x16x32_bf16 v[136:139], a[236:239], a[12:15], 0
    ds_read_b64_tr_b16 a[224:225], v18 offset:24576
    v_mfma_f32_16x16x32_bf16 v[120:123], a[236:239], a[8:11], 0
    ds_read_b64_tr_b16 a[226:227], v18 offset:25088
    buffer_load_dwordx4 v6, s[12:15], s49 offen offset:0 lds
    v_mfma_f32_16x16x32_bf16 v[104:107], a[236:239], a[4:7], 0
    v_mfma_f32_16x16x32_bf16 v[88:91], a[236:239], a[0:3], 0
    s_waitcnt lgkmcnt(12)
    v_mfma_f32_16x16x32_bf16 v[92:95], a[240:243], a[0:3], 0
    ds_read_b64_tr_b16 a[228:229], v19 offset:24576
    buffer_load_dwordx4 v7, s[12:15], s49 offen offset:1024 lds
    v_mfma_f32_16x16x32_bf16 v[108:111], a[240:243], a[4:7], 0
    ds_read_b64_tr_b16 a[230:231], v19 offset:25088
    v_mfma_f32_16x16x32_bf16 v[124:127], a[240:243], a[8:11], 0
    s_add_u32 m0, s53, 88064
    v_mfma_f32_16x16x32_bf16 v[140:143], a[240:243], a[12:15], 0
    s_waitcnt lgkmcnt(12)
    v_mfma_f32_16x16x32_bf16 v[144:147], a[244:247], a[12:15], 0
    ds_read_b64_tr_b16 a[232:233], v18 offset:26624
    v_mfma_f32_16x16x32_bf16 v[128:131], a[244:247], a[8:11], 0
    ds_read_b64_tr_b16 a[234:235], v18 offset:27136
    s_add_u32 s49, s49, s52
    v_mfma_f32_16x16x32_bf16 v[112:115], a[244:247], a[4:7], 0
    ds_read_b64_tr_b16 a[236:237], v19 offset:26624
    v_mfma_f32_16x16x32_bf16 v[96:99], a[244:247], a[0:3], 0
    ds_read_b64_tr_b16 a[238:239], v19 offset:27136
    s_waitcnt lgkmcnt(13)
    v_mfma_f32_16x16x32_bf16 v[52:55], a[248:251], a[16:19], v[52:55]
    buffer_load_dwordx4 v6, s[16:19], s50 offen offset:0 lds
    s_waitcnt lgkmcnt(12)
    v_mfma_f32_16x16x32_bf16 v[60:63], a[248:251], a[20:23], v[60:63]
    s_waitcnt lgkmcnt(9)
    v_mfma_f32_16x16x32_bf16 v[68:71], a[248:251], a[24:27], v[68:71]
    buffer_load_dwordx4 v7, s[16:19], s50 offen offset:1024 lds
    s_waitcnt lgkmcnt(8)
    v_mfma_f32_16x16x32_bf16 v[76:79], a[248:251], a[28:31], v[76:79]
    v_mfma_f32_16x16x32_bf16 v[80:83], a[252:255], a[28:31], v[80:83]
    s_waitcnt vmcnt(12) lgkmcnt(0)
    s_barrier
    ds_read_b64_tr_b16 a[240:241], v18 offset:49152
    v_mfma_f32_16x16x32_bf16 v[72:75], a[252:255], a[24:27], v[72:75]
    ds_read_b64_tr_b16 a[242:243], v18 offset:49664
    s_add_u32 m0, s53, 90112
    v_mfma_f32_16x16x32_bf16 v[64:67], a[252:255], a[20:23], v[64:67]
    ds_read_b128 a[32:35], v12 offset:40960
    v_mfma_f32_16x16x32_bf16 v[56:59], a[252:255], a[16:19], v[56:59]
    ds_read_b128 a[36:39], v12 offset:43008
    v_mfma_f32_16x16x32_bf16 v[84:87], a[224:227], a[16:19], v[84:87]
    ds_read_b64_tr_b16 a[244:245], v19 offset:49152
    s_add_u32 s50, s50, s52
    v_mfma_f32_16x16x32_bf16 v[100:103], a[224:227], a[20:23], v[100:103]
    ds_read_b64_tr_b16 a[246:247], v19 offset:49664
    v_mfma_f32_16x16x32_bf16 v[116:119], a[224:227], a[24:27], v[116:119]
    ds_read_b128 a[40:43], v12 offset:51200
    buffer_load_dwordx4 v8, s[20:23], s51 offen offset:0 lds
    v_mfma_f32_16x16x32_bf16 v[132:135], a[224:227], a[28:31], v[132:135]
    ds_read_b128 a[44:47], v12 offset:53248
    v_mfma_f32_16x16x32_bf16 v[136:139], a[228:231], a[28:31], v[136:139]
    ds_read_b64_tr_b16 a[248:249], v18 offset:45056
    v_mfma_f32_16x16x32_bf16 v[120:123], a[228:231], a[24:27], v[120:123]
    ds_read_b64_tr_b16 a[250:251], v18 offset:45568
    buffer_load_dwordx4 v9, s[20:23], s51 offen offset:1024 lds
    v_mfma_f32_16x16x32_bf16 v[104:107], a[228:231], a[20:23], v[104:107]
    v_mfma_f32_16x16x32_bf16 v[88:91], a[228:231], a[16:19], v[88:91]
    v_mfma_f32_16x16x32_bf16 v[92:95], a[232:235], a[16:19], v[92:95]
    ds_read_b64_tr_b16 a[252:253], v19 offset:45056
    s_add_u32 s51, s51, 172032
    v_mfma_f32_16x16x32_bf16 v[108:111], a[232:235], a[20:23], v[108:111]
    ds_read_b64_tr_b16 a[254:255], v19 offset:45568
    v_mfma_f32_16x16x32_bf16 v[124:127], a[232:235], a[24:27], v[124:127]
    v_mfma_f32_16x16x32_bf16 v[140:143], a[232:235], a[28:31], v[140:143]
    v_mfma_f32_16x16x32_bf16 v[144:147], a[236:239], a[28:31], v[144:147]
    ds_read_b64_tr_b16 a[224:225], v18 offset:47104
    v_mfma_f32_16x16x32_bf16 v[128:131], a[236:239], a[24:27], v[128:131]
    ds_read_b64_tr_b16 a[226:227], v18 offset:47616
    v_mfma_f32_16x16x32_bf16 v[112:115], a[236:239], a[20:23], v[112:115]
    v_mfma_f32_16x16x32_bf16 v[96:99], a[236:239], a[16:19], v[96:99]
    s_waitcnt lgkmcnt(11)
    v_mfma_f32_16x16x32_bf16 v[52:55], a[240:243], a[32:35], v[52:55]
    ds_read_b64_tr_b16 a[228:229], v19 offset:47104
    s_add_u32 m0, s53, 122880
    s_waitcnt lgkmcnt(11)
    v_mfma_f32_16x16x32_bf16 v[60:63], a[240:243], a[36:39], v[60:63]
    ds_read_b64_tr_b16 a[230:231], v19 offset:47616
    buffer_load_dwordx4 v2, s[8:11], s48 offen offset:0 lds
    s_waitcnt lgkmcnt(9)
    v_mfma_f32_16x16x32_bf16 v[68:71], a[240:243], a[40:43], v[68:71]
    s_mov_b64 exec, 0x2aaa
    buffer_load_dword v45, v201, s[12:15], 0 offen
    buffer_load_dword v45, v202, s[16:19], 0 offen
    s_mov_b64 exec, -1
    s_waitcnt lgkmcnt(8)
    v_mfma_f32_16x16x32_bf16 v[76:79], a[240:243], a[44:47], v[76:79]
    buffer_load_dwordx4 v3, s[8:11], s48 offen offset:1024 lds
    v_mfma_f32_16x16x32_bf16 v[80:83], a[244:247], a[44:47], v[80:83]
    ds_read_b64_tr_b16 a[232:233], v20 offset:4096
    buffer_load_dwordx4 v4, s[8:11], s48 offen offset:2048 lds
    v_mfma_f32_16x16x32_bf16 v[72:75], a[244:247], a[40:43], v[72:75]
    ds_read_b64_tr_b16 a[234:235], v20 offset:4608
    buffer_load_dwordx4 v5, s[8:11], s48 offen offset:3072 lds
    v_mfma_f32_16x16x32_bf16 v[64:67], a[244:247], a[36:39], v[64:67]
    ds_read_b128 a[48:51], v13 offset:40960
    v_mfma_f32_16x16x32_bf16 v[56:59], a[244:247], a[32:35], v[56:59]
    ds_read_b128 a[52:55], v13 offset:43008
    s_waitcnt lgkmcnt(10)
    v_mfma_f32_16x16x32_bf16 v[84:87], a[248:251], a[32:35], v[84:87]
    ds_read_b64_tr_b16 a[236:237], v21 offset:4096
    s_add_u32 m0, s53, 126976
    v_mfma_f32_16x16x32_bf16 v[100:103], a[248:251], a[36:39], v[100:103]
    ds_read_b64_tr_b16 a[238:239], v21 offset:4608
    v_mfma_f32_16x16x32_bf16 v[116:119], a[248:251], a[40:43], v[116:119]
    ds_read_b128 a[56:59], v13 offset:51200
    s_add_u32 s48, s48, 0x80
    v_mfma_f32_16x16x32_bf16 v[132:135], a[248:251], a[44:47], v[132:135]
    ds_read_b128 a[60:63], v13 offset:53248
    s_waitcnt lgkmcnt(12)
    v_mfma_f32_16x16x32_bf16 v[136:139], a[252:255], a[44:47], v[136:139]
    ds_read_b64_tr_b16 a[240:241], v20 offset:0
    v_mfma_f32_16x16x32_bf16 v[120:123], a[252:255], a[40:43], v[120:123]
    ds_read_b64_tr_b16 a[242:243], v20 offset:512
    buffer_load_dwordx4 v6, s[12:15], s49 offen offset:0 lds
    v_mfma_f32_16x16x32_bf16 v[104:107], a[252:255], a[36:39], v[104:107]
    v_mfma_f32_16x16x32_bf16 v[88:91], a[252:255], a[32:35], v[88:91]
    s_waitcnt lgkmcnt(12)
    v_mfma_f32_16x16x32_bf16 v[92:95], a[224:227], a[32:35], v[92:95]
    ds_read_b64_tr_b16 a[244:245], v21 offset:0
    buffer_load_dwordx4 v7, s[12:15], s49 offen offset:1024 lds
    v_mfma_f32_16x16x32_bf16 v[108:111], a[224:227], a[36:39], v[108:111]
    ds_read_b64_tr_b16 a[246:247], v21 offset:512
    v_mfma_f32_16x16x32_bf16 v[124:127], a[224:227], a[40:43], v[124:127]
    s_add_u32 m0, s53, 129024
    v_mfma_f32_16x16x32_bf16 v[140:143], a[224:227], a[44:47], v[140:143]
    s_waitcnt lgkmcnt(12)
    v_mfma_f32_16x16x32_bf16 v[144:147], a[228:231], a[44:47], v[144:147]
    ds_read_b64_tr_b16 a[248:249], v20 offset:2048
    v_mfma_f32_16x16x32_bf16 v[128:131], a[228:231], a[40:43], v[128:131]
    ds_read_b64_tr_b16 a[250:251], v20 offset:2560
    s_add_u32 s49, s49, s52
    v_mfma_f32_16x16x32_bf16 v[112:115], a[228:231], a[36:39], v[112:115]
    ds_read_b64_tr_b16 a[252:253], v21 offset:2048
    v_mfma_f32_16x16x32_bf16 v[96:99], a[228:231], a[32:35], v[96:99]
    ds_read_b64_tr_b16 a[254:255], v21 offset:2560
    s_waitcnt lgkmcnt(13)
    v_mfma_f32_16x16x32_bf16 v[52:55], a[232:235], a[48:51], v[52:55]
    buffer_load_dwordx4 v6, s[16:19], s50 offen offset:0 lds
    s_waitcnt lgkmcnt(12)
    v_mfma_f32_16x16x32_bf16 v[60:63], a[232:235], a[52:55], v[60:63]
    s_waitcnt lgkmcnt(9)
    v_mfma_f32_16x16x32_bf16 v[68:71], a[232:235], a[56:59], v[68:71]
    buffer_load_dwordx4 v7, s[16:19], s50 offen offset:1024 lds
    s_waitcnt lgkmcnt(8)
    v_mfma_f32_16x16x32_bf16 v[76:79], a[232:235], a[60:63], v[76:79]
    v_mfma_f32_16x16x32_bf16 v[80:83], a[236:239], a[60:63], v[80:83]
    s_waitcnt vmcnt(10) lgkmcnt(0)
    s_barrier
    ds_read_b64_tr_b16 a[224:225], v20 offset:24576
    v_mfma_f32_16x16x32_bf16 v[72:75], a[236:239], a[56:59], v[72:75]
    ds_read_b64_tr_b16 a[226:227], v20 offset:25088
    s_add_u32 m0, s53, 131072
    v_mfma_f32_16x16x32_bf16 v[64:67], a[236:239], a[52:55], v[64:67]
    ds_read_b128 a[64:67], v14 offset:16384
    v_mfma_f32_16x16x32_bf16 v[56:59], a[236:239], a[48:51], v[56:59]
    ds_read_b128 a[68:71], v14 offset:18432
    v_mfma_f32_16x16x32_bf16 v[84:87], a[240:243], a[48:51], v[84:87]
    ds_read_b64_tr_b16 a[228:229], v21 offset:24576
    s_add_u32 s50, s50, s52
    v_mfma_f32_16x16x32_bf16 v[100:103], a[240:243], a[52:55], v[100:103]
    ds_read_b64_tr_b16 a[230:231], v21 offset:25088
    v_mfma_f32_16x16x32_bf16 v[116:119], a[240:243], a[56:59], v[116:119]
    ds_read_b128 a[72:75], v14 offset:26624
    buffer_load_dwordx4 v8, s[20:23], s51 offen offset:0 lds
    v_mfma_f32_16x16x32_bf16 v[132:135], a[240:243], a[60:63], v[132:135]
    ds_read_b128 a[76:79], v14 offset:28672
    v_mfma_f32_16x16x32_bf16 v[136:139], a[244:247], a[60:63], v[136:139]
    ds_read_b64_tr_b16 a[232:233], v20 offset:20480
    v_mfma_f32_16x16x32_bf16 v[120:123], a[244:247], a[56:59], v[120:123]
    ds_read_b64_tr_b16 a[234:235], v20 offset:20992
    buffer_load_dwordx4 v9, s[20:23], s51 offen offset:1024 lds
    v_mfma_f32_16x16x32_bf16 v[104:107], a[244:247], a[52:55], v[104:107]
    v_mfma_f32_16x16x32_bf16 v[88:91], a[244:247], a[48:51], v[88:91]
    v_mfma_f32_16x16x32_bf16 v[92:95], a[248:251], a[48:51], v[92:95]
    ds_read_b64_tr_b16 a[236:237], v21 offset:20480
    s_add_u32 s51, s51, 172032
    v_mfma_f32_16x16x32_bf16 v[108:111], a[248:251], a[52:55], v[108:111]
    ds_read_b64_tr_b16 a[238:239], v21 offset:20992
    v_mfma_f32_16x16x32_bf16 v[124:127], a[248:251], a[56:59], v[124:127]
    v_mfma_f32_16x16x32_bf16 v[140:143], a[248:251], a[60:63], v[140:143]
    v_mfma_f32_16x16x32_bf16 v[144:147], a[252:255], a[60:63], v[144:147]
    ds_read_b64_tr_b16 a[240:241], v20 offset:22528
    v_mfma_f32_16x16x32_bf16 v[128:131], a[252:255], a[56:59], v[128:131]
    ds_read_b64_tr_b16 a[242:243], v20 offset:23040
    v_mfma_f32_16x16x32_bf16 v[112:115], a[252:255], a[52:55], v[112:115]
    v_mfma_f32_16x16x32_bf16 v[96:99], a[252:255], a[48:51], v[96:99]
    s_waitcnt lgkmcnt(11)
    v_mfma_f32_16x16x32_bf16 v[52:55], a[224:227], a[64:67], v[52:55]
    ds_read_b64_tr_b16 a[244:245], v21 offset:22528
    s_add_u32 m0, s53, 0
    s_waitcnt lgkmcnt(11)
    v_mfma_f32_16x16x32_bf16 v[60:63], a[224:227], a[68:71], v[60:63]
    ds_read_b64_tr_b16 a[246:247], v21 offset:23040
    buffer_load_dwordx4 v2, s[8:11], s48 offen offset:0 lds
    s_waitcnt lgkmcnt(9)
    v_mfma_f32_16x16x32_bf16 v[68:71], a[224:227], a[72:75], v[68:71]
    buffer_load_dwordx4 v3, s[8:11], s48 offen offset:1024 lds
    s_waitcnt lgkmcnt(8)
    v_mfma_f32_16x16x32_bf16 v[76:79], a[224:227], a[76:79], v[76:79]
    buffer_load_dwordx4 v4, s[8:11], s48 offen offset:2048 lds
    v_mfma_f32_16x16x32_bf16 v[80:83], a[228:231], a[76:79], v[80:83]
    ds_read_b64_tr_b16 a[248:249], v20 offset:45056
    v_mfma_f32_16x16x32_bf16 v[72:75], a[228:231], a[72:75], v[72:75]
    ds_read_b64_tr_b16 a[250:251], v20 offset:45568
    buffer_load_dwordx4 v5, s[8:11], s48 offen offset:3072 lds
    v_mfma_f32_16x16x32_bf16 v[64:67], a[228:231], a[68:71], v[64:67]
    ds_read_b128 a[80:83], v15 offset:16384
    v_mfma_f32_16x16x32_bf16 v[56:59], a[228:231], a[64:67], v[56:59]
    ds_read_b128 a[84:87], v15 offset:18432
    s_waitcnt lgkmcnt(10)
    v_mfma_f32_16x16x32_bf16 v[84:87], a[232:235], a[64:67], v[84:87]
    ds_read_b64_tr_b16 a[252:253], v21 offset:45056
    s_add_u32 m0, s53, 4096
    v_mfma_f32_16x16x32_bf16 v[100:103], a[232:235], a[68:71], v[100:103]
    ds_read_b64_tr_b16 a[254:255], v21 offset:45568
    v_mfma_f32_16x16x32_bf16 v[116:119], a[232:235], a[72:75], v[116:119]
    ds_read_b128 a[88:91], v15 offset:26624
    s_add_u32 s48, s48, 0x80
    v_mfma_f32_16x16x32_bf16 v[132:135], a[232:235], a[76:79], v[132:135]
    ds_read_b128 a[92:95], v15 offset:28672
    s_waitcnt lgkmcnt(12)
    v_mfma_f32_16x16x32_bf16 v[136:139], a[236:239], a[76:79], v[136:139]
    ds_read_b64_tr_b16 a[224:225], v20 offset:40960
    v_mfma_f32_16x16x32_bf16 v[120:123], a[236:239], a[72:75], v[120:123]
    ds_read_b64_tr_b16 a[226:227], v20 offset:41472
    buffer_load_dwordx4 v6, s[12:15], s49 offen offset:0 lds
    v_mfma_f32_16x16x32_bf16 v[104:107], a[236:239], a[68:71], v[104:107]
    v_mfma_f32_16x16x32_bf16 v[88:91], a[236:239], a[64:67], v[88:91]
    s_waitcnt lgkmcnt(12)
    v_mfma_f32_16x16x32_bf16 v[92:95], a[240:243], a[64:67], v[92:95]
    ds_read_b64_tr_b16 a[228:229], v21 offset:40960
    buffer_load_dwordx4 v7, s[12:15], s49 offen offset:1024 lds
    v_mfma_f32_16x16x32_bf16 v[108:111], a[240:243], a[68:71], v[108:111]
    ds_read_b64_tr_b16 a[230:231], v21 offset:41472
    v_mfma_f32_16x16x32_bf16 v[124:127], a[240:243], a[72:75], v[124:127]
    v_mfma_f32_16x16x32_bf16 v[140:143], a[240:243], a[76:79], v[140:143]
    s_add_u32 m0, s53, 6144
    s_waitcnt lgkmcnt(12)
    v_mfma_f32_16x16x32_bf16 v[144:147], a[244:247], a[76:79], v[144:147]
    ds_read_b64_tr_b16 a[232:233], v20 offset:43008
    v_mfma_f32_16x16x32_bf16 v[128:131], a[244:247], a[72:75], v[128:131]
    ds_read_b64_tr_b16 a[234:235], v20 offset:43520
    s_add_u32 s49, s49, s52
    v_mfma_f32_16x16x32_bf16 v[112:115], a[244:247], a[68:71], v[112:115]
    ds_read_b64_tr_b16 a[236:237], v21 offset:43008
    v_mfma_f32_16x16x32_bf16 v[96:99], a[244:247], a[64:67], v[96:99]
    ds_read_b64_tr_b16 a[238:239], v21 offset:43520
    s_waitcnt lgkmcnt(13)
    v_mfma_f32_16x16x32_bf16 v[52:55], a[248:251], a[80:83], v[52:55]
    buffer_load_dwordx4 v6, s[16:19], s50 offen offset:0 lds
    s_waitcnt lgkmcnt(12)
    v_mfma_f32_16x16x32_bf16 v[60:63], a[248:251], a[84:87], v[60:63]
    s_waitcnt lgkmcnt(9)
    v_mfma_f32_16x16x32_bf16 v[68:71], a[248:251], a[88:91], v[68:71]
    s_mov_b64 exec, 0x1fff
    buffer_load_dword v45, v204, s[28:31], 0 offen
    s_mov_b64 exec, 0xf
    buffer_load_dword v45, v205, s[32:35], 0 offen
    s_mov_b64 exec, -1
    s_waitcnt lgkmcnt(8)
    v_mfma_f32_16x16x32_bf16 v[76:79], a[248:251], a[92:95], v[76:79]
    buffer_load_dwordx4 v7, s[16:19], s50 offen offset:1024 lds
    v_mfma_f32_16x16x32_bf16 v[80:83], a[252:255], a[92:95], v[80:83]
    s_waitcnt vmcnt(10) lgkmcnt(0)
    s_barrier
    ds_read_b64_tr_b16 a[240:241], v22 offset:0
    v_mfma_f32_16x16x32_bf16 v[72:75], a[252:255], a[88:91], v[72:75]
    ds_read_b64_tr_b16 a[242:243], v22 offset:512
    s_add_u32 m0, s53, 8192
    v_mfma_f32_16x16x32_bf16 v[64:67], a[252:255], a[84:87], v[64:67]
    ds_read_b128 a[96:99], v14 offset:57344
    v_mfma_f32_16x16x32_bf16 v[56:59], a[252:255], a[80:83], v[56:59]
    ds_read_b128 a[100:103], v14 offset:59392
    v_mfma_f32_16x16x32_bf16 v[84:87], a[224:227], a[80:83], v[84:87]
    ds_read_b64_tr_b16 a[244:245], v23 offset:0
    s_add_u32 s50, s50, s52
    v_mfma_f32_16x16x32_bf16 v[100:103], a[224:227], a[84:87], v[100:103]
    ds_read_b64_tr_b16 a[246:247], v23 offset:512
    v_mfma_f32_16x16x32_bf16 v[116:119], a[224:227], a[88:91], v[116:119]
    ds_read_b128 a[104:107], v16 offset:2048
    v_mfma_f32_16x16x32_bf16 v[132:135], a[224:227], a[92:95], v[132:135]
    ds_read_b128 a[108:111], v16 offset:4096
    buffer_load_dwordx4 v8, s[20:23], s51 offen offset:0 lds
    v_mfma_f32_16x16x32_bf16 v[136:139], a[228:231], a[92:95], v[136:139]
    ds_read_b64_tr_b16 a[248:249], v20 offset:61440
    v_mfma_f32_16x16x32_bf16 v[120:123], a[228:231], a[88:91], v[120:123]
    ds_read_b64_tr_b16 a[250:251], v20 offset:61952
    buffer_load_dwordx4 v9, s[20:23], s51 offen offset:1024 lds
    v_mfma_f32_16x16x32_bf16 v[104:107], a[228:231], a[84:87], v[104:107]
    v_mfma_f32_16x16x32_bf16 v[88:91], a[228:231], a[80:83], v[88:91]
    v_mfma_f32_16x16x32_bf16 v[92:95], a[232:235], a[80:83], v[92:95]
    ds_read_b64_tr_b16 a[252:253], v21 offset:61440
    s_add_u32 s51, s51, 172032
    v_mfma_f32_16x16x32_bf16 v[108:111], a[232:235], a[84:87], v[108:111]
    ds_read_b64_tr_b16 a[254:255], v21 offset:61952
    v_mfma_f32_16x16x32_bf16 v[124:127], a[232:235], a[88:91], v[124:127]
    v_mfma_f32_16x16x32_bf16 v[140:143], a[232:235], a[92:95], v[140:143]
    v_mfma_f32_16x16x32_bf16 v[144:147], a[236:239], a[92:95], v[144:147]
    ds_read_b64_tr_b16 a[224:225], v20 offset:63488
    v_mfma_f32_16x16x32_bf16 v[128:131], a[236:239], a[88:91], v[128:131]
    ds_read_b64_tr_b16 a[226:227], v20 offset:64000
    v_mfma_f32_16x16x32_bf16 v[112:115], a[236:239], a[84:87], v[112:115]
    v_mfma_f32_16x16x32_bf16 v[96:99], a[236:239], a[80:83], v[96:99]
    s_waitcnt lgkmcnt(11)
    v_mfma_f32_16x16x32_bf16 v[52:55], a[240:243], a[96:99], v[52:55]
    ds_read_b64_tr_b16 a[228:229], v21 offset:63488
    s_add_u32 m0, s53, 40960
    s_waitcnt lgkmcnt(11)
    v_mfma_f32_16x16x32_bf16 v[60:63], a[240:243], a[100:103], v[60:63]
    ds_read_b64_tr_b16 a[230:231], v21 offset:64000
    buffer_load_dwordx4 v2, s[8:11], s48 offen offset:0 lds
    s_waitcnt lgkmcnt(9)
    v_mfma_f32_16x16x32_bf16 v[68:71], a[240:243], a[104:107], v[68:71]
    buffer_load_dwordx4 v3, s[8:11], s48 offen offset:1024 lds
    s_waitcnt lgkmcnt(8)
    v_mfma_f32_16x16x32_bf16 v[76:79], a[240:243], a[108:111], v[76:79]
    buffer_load_dwordx4 v4, s[8:11], s48 offen offset:2048 lds
    v_mfma_f32_16x16x32_bf16 v[80:83], a[244:247], a[108:111], v[80:83]
    ds_read_b64_tr_b16 a[232:233], v22 offset:20480
    v_mfma_f32_16x16x32_bf16 v[72:75], a[244:247], a[104:107], v[72:75]
    ds_read_b64_tr_b16 a[234:235], v22 offset:20992
    buffer_load_dwordx4 v5, s[8:11], s48 offen offset:3072 lds
    v_mfma_f32_16x16x32_bf16 v[64:67], a[244:247], a[100:103], v[64:67]
    ds_read_b128 a[112:115], v15 offset:57344
    v_mfma_f32_16x16x32_bf16 v[56:59], a[244:247], a[96:99], v[56:59]
    ds_read_b128 a[116:119], v15 offset:59392
    s_waitcnt lgkmcnt(10)
    v_mfma_f32_16x16x32_bf16 v[84:87], a[248:251], a[96:99], v[84:87]
    ds_read_b64_tr_b16 a[236:237], v23 offset:20480
    s_add_u32 m0, s53, 45056
    v_mfma_f32_16x16x32_bf16 v[100:103], a[248:251], a[100:103], v[100:103]
    ds_read_b64_tr_b16 a[238:239], v23 offset:20992
    v_mfma_f32_16x16x32_bf16 v[116:119], a[248:251], a[104:107], v[116:119]
    ds_read_b128 a[120:123], v17 offset:2048
    v_mfma_f32_16x16x32_bf16 v[132:135], a[248:251], a[108:111], v[132:135]
    ds_read_b128 a[124:127], v17 offset:4096
    s_add_u32 s48, s48, 0x80
    s_waitcnt lgkmcnt(12)
    v_mfma_f32_16x16x32_bf16 v[136:139], a[252:255], a[108:111], v[136:139]
    ds_read_b64_tr_b16 a[240:241], v22 offset:16384
    v_mfma_f32_16x16x32_bf16 v[120:123], a[252:255], a[104:107], v[120:123]
    ds_read_b64_tr_b16 a[242:243], v22 offset:16896
    buffer_load_dwordx4 v6, s[12:15], s49 offen offset:0 lds
    v_mfma_f32_16x16x32_bf16 v[104:107], a[252:255], a[100:103], v[104:107]
    v_mfma_f32_16x16x32_bf16 v[88:91], a[252:255], a[96:99], v[88:91]
    s_waitcnt lgkmcnt(12)
    v_mfma_f32_16x16x32_bf16 v[92:95], a[224:227], a[96:99], v[92:95]
    ds_read_b64_tr_b16 a[244:245], v23 offset:16384
    buffer_load_dwordx4 v7, s[12:15], s49 offen offset:1024 lds
    v_mfma_f32_16x16x32_bf16 v[108:111], a[224:227], a[100:103], v[108:111]
    ds_read_b64_tr_b16 a[246:247], v23 offset:16896
    v_mfma_f32_16x16x32_bf16 v[124:127], a[224:227], a[104:107], v[124:127]
    global_load_dword v48, v49, s[40:41] sc1
    v_mfma_f32_16x16x32_bf16 v[140:143], a[224:227], a[108:111], v[140:143]
    s_add_u32 m0, s53, 47104
    s_waitcnt lgkmcnt(12)
    v_mfma_f32_16x16x32_bf16 v[144:147], a[228:231], a[108:111], v[144:147]
    ds_read_b64_tr_b16 a[248:249], v22 offset:18432
    v_mfma_f32_16x16x32_bf16 v[128:131], a[228:231], a[104:107], v[128:131]
    ds_read_b64_tr_b16 a[250:251], v22 offset:18944
    s_add_u32 s49, s49, s52
    v_mfma_f32_16x16x32_bf16 v[112:115], a[228:231], a[100:103], v[112:115]
    ds_read_b64_tr_b16 a[252:253], v23 offset:18432
    v_mfma_f32_16x16x32_bf16 v[96:99], a[228:231], a[96:99], v[96:99]
    ds_read_b64_tr_b16 a[254:255], v23 offset:18944
    s_waitcnt lgkmcnt(13)
    v_mfma_f32_16x16x32_bf16 v[52:55], a[232:235], a[112:115], v[52:55]
    buffer_load_dwordx4 v6, s[16:19], s50 offen offset:0 lds
    s_waitcnt lgkmcnt(12)
    v_mfma_f32_16x16x32_bf16 v[60:63], a[232:235], a[116:119], v[60:63]
    s_waitcnt lgkmcnt(9)
    v_mfma_f32_16x16x32_bf16 v[68:71], a[232:235], a[120:123], v[68:71]
    s_waitcnt lgkmcnt(8)
    v_mfma_f32_16x16x32_bf16 v[76:79], a[232:235], a[124:127], v[76:79]
    buffer_load_dwordx4 v7, s[16:19], s50 offen offset:1024 lds
    v_mfma_f32_16x16x32_bf16 v[80:83], a[236:239], a[124:127], v[80:83]
    s_waitcnt vmcnt(9) lgkmcnt(0)
    s_barrier
    ds_read_b64_tr_b16 a[224:225], v18 offset:8192
    v_mfma_f32_16x16x32_bf16 v[72:75], a[236:239], a[120:123], v[72:75]
    ds_read_b64_tr_b16 a[226:227], v18 offset:8704
    s_add_u32 m0, s53, 49152
    v_mfma_f32_16x16x32_bf16 v[64:67], a[236:239], a[116:119], v[64:67]
    ds_read_b128 a[128:131], v12 offset:0
    v_mfma_f32_16x16x32_bf16 v[56:59], a[236:239], a[112:115], v[56:59]
    ds_read_b128 a[132:135], v12 offset:2048
    v_mfma_f32_16x16x32_bf16 v[84:87], a[240:243], a[112:115], v[84:87]
    ds_read_b64_tr_b16 a[228:229], v19 offset:8192
    s_add_u32 s50, s50, s52
    v_mfma_f32_16x16x32_bf16 v[100:103], a[240:243], a[116:119], v[100:103]
    ds_read_b64_tr_b16 a[230:231], v19 offset:8704
    v_mfma_f32_16x16x32_bf16 v[116:119], a[240:243], a[120:123], v[116:119]
    ds_read_b128 a[136:139], v12 offset:10240
    v_mfma_f32_16x16x32_bf16 v[132:135], a[240:243], a[124:127], v[132:135]
    ds_read_b128 a[140:143], v12 offset:12288
    buffer_load_dwordx4 v8, s[20:23], s51 offen offset:0 lds
    v_mfma_f32_16x16x32_bf16 v[136:139], a[244:247], a[124:127], v[136:139]
    ds_read_b64_tr_b16 a[232:233], v18 offset:4096
    v_mfma_f32_16x16x32_bf16 v[120:123], a[244:247], a[120:123], v[120:123]
    ds_read_b64_tr_b16 a[234:235], v18 offset:4608
    buffer_load_dwordx4 v9, s[20:23], s51 offen offset:1024 lds
    v_mfma_f32_16x16x32_bf16 v[104:107], a[244:247], a[116:119], v[104:107]
    v_mfma_f32_16x16x32_bf16 v[88:91], a[244:247], a[112:115], v[88:91]
    v_mfma_f32_16x16x32_bf16 v[92:95], a[248:251], a[112:115], v[92:95]
    ds_read_b64_tr_b16 a[236:237], v19 offset:4096
    s_add_u32 s51, s51, 172032
    v_mfma_f32_16x16x32_bf16 v[108:111], a[248:251], a[116:119], v[108:111]
    ds_read_b64_tr_b16 a[238:239], v19 offset:4608
    v_mfma_f32_16x16x32_bf16 v[124:127], a[248:251], a[120:123], v[124:127]
    v_mfma_f32_16x16x32_bf16 v[140:143], a[248:251], a[124:127], v[140:143]
    v_mfma_f32_16x16x32_bf16 v[144:147], a[252:255], a[124:127], v[144:147]
    ds_read_b64_tr_b16 a[240:241], v18 offset:6144
    v_mfma_f32_16x16x32_bf16 v[128:131], a[252:255], a[120:123], v[128:131]
    ds_read_b64_tr_b16 a[242:243], v18 offset:6656
    v_mfma_f32_16x16x32_bf16 v[112:115], a[252:255], a[116:119], v[112:115]
    s_lshr_b32 s86, s2, 3
    s_and_b32 s87, s2, 7
    s_mul_i32 s88, s86, 37
    s_lshr_b32 s88, s88, 8
    v_mfma_f32_16x16x32_bf16 v[96:99], a[252:255], a[112:115], v[96:99]
    s_waitcnt lgkmcnt(11)
    v_mfma_f32_16x16x32_bf16 v[52:55], a[224:227], a[128:131], v[52:55]
    ds_read_b64_tr_b16 a[244:245], v19 offset:6144
    s_add_u32 m0, s53, 81920
    s_waitcnt lgkmcnt(11)
    v_mfma_f32_16x16x32_bf16 v[60:63], a[224:227], a[132:135], v[60:63]
    ds_read_b64_tr_b16 a[246:247], v19 offset:6656
    buffer_load_dwordx4 v2, s[8:11], s48 offen offset:0 lds
    s_waitcnt lgkmcnt(9)
    v_mfma_f32_16x16x32_bf16 v[68:71], a[224:227], a[136:139], v[68:71]
    buffer_load_dwordx4 v3, s[8:11], s48 offen offset:1024 lds
    s_waitcnt lgkmcnt(8)
    v_mfma_f32_16x16x32_bf16 v[76:79], a[224:227], a[140:143], v[76:79]
    buffer_load_dwordx4 v4, s[8:11], s48 offen offset:2048 lds
    v_mfma_f32_16x16x32_bf16 v[80:83], a[228:231], a[140:143], v[80:83]
    ds_read_b64_tr_b16 a[248:249], v18 offset:28672
    v_mfma_f32_16x16x32_bf16 v[72:75], a[228:231], a[136:139], v[72:75]
    ds_read_b64_tr_b16 a[250:251], v18 offset:29184
    buffer_load_dwordx4 v5, s[8:11], s48 offen offset:3072 lds
    v_mfma_f32_16x16x32_bf16 v[64:67], a[228:231], a[132:135], v[64:67]
    ds_read_b128 a[144:147], v13 offset:0
    v_mfma_f32_16x16x32_bf16 v[56:59], a[228:231], a[128:131], v[56:59]
    ds_read_b128 a[148:151], v13 offset:2048
    s_waitcnt lgkmcnt(10)
    v_mfma_f32_16x16x32_bf16 v[84:87], a[232:235], a[128:131], v[84:87]
    ds_read_b64_tr_b16 a[252:253], v19 offset:28672
    s_add_u32 m0, s53, 86016
    s_mul_i32 s89, s88, 7
    s_sub_u32 s89, s86, s89
    s_cmp_lt_u32 s86, 28
    s_cselect_b32 s76, 1, 0
    v_mfma_f32_16x16x32_bf16 v[100:103], a[232:235], a[132:135], v[100:103]
    ds_read_b64_tr_b16 a[254:255], v19 offset:29184
    s_min_u32 s88, s88, 3
    s_lshl_b32 s87, s87, 2
    s_add_u32 s87, s87, s88
    v_mfma_f32_16x16x32_bf16 v[116:119], a[232:235], a[136:139], v[116:119]
    ds_read_b128 a[152:155], v13 offset:10240
    s_mul_i32 s92, s44, 401408
    s_lshl_b32 s89, s89, 7
    s_add_u32 s77, s92, s89
    v_mfma_f32_16x16x32_bf16 v[132:135], a[232:235], a[140:143], v[132:135]
    ds_read_b128 a[156:159], v13 offset:12288
    s_add_u32 s48, s48, 0x80
    s_waitcnt lgkmcnt(12)
    v_mfma_f32_16x16x32_bf16 v[136:139], a[236:239], a[140:143], v[136:139]
    ds_read_b64_tr_b16 a[224:225], v18 offset:24576
    v_mfma_f32_16x16x32_bf16 v[120:123], a[236:239], a[136:139], v[120:123]
    ds_read_b64_tr_b16 a[226:227], v18 offset:25088
    buffer_load_dwordx4 v6, s[12:15], s49 offen offset:0 lds
    v_mfma_f32_16x16x32_bf16 v[104:107], a[236:239], a[132:135], v[104:107]
    s_mul_i32 s92, s44, 100352
    s_add_u32 s79, s92, s89
    v_mfma_f32_16x16x32_bf16 v[88:91], a[236:239], a[128:131], v[88:91]
    s_waitcnt lgkmcnt(12)
    v_mfma_f32_16x16x32_bf16 v[92:95], a[240:243], a[128:131], v[92:95]
    ds_read_b64_tr_b16 a[228:229], v19 offset:24576
    buffer_load_dwordx4 v7, s[12:15], s49 offen offset:1024 lds
    v_mfma_f32_16x16x32_bf16 v[108:111], a[240:243], a[132:135], v[108:111]
    ds_read_b64_tr_b16 a[230:231], v19 offset:25088
    v_mfma_f32_16x16x32_bf16 v[124:127], a[240:243], a[136:139], v[124:127]
    v_mfma_f32_16x16x32_bf16 v[140:143], a[240:243], a[140:143], v[140:143]
    s_add_u32 m0, s53, 88064
    s_mul_i32 s80, s44, 12288
    s_add_u32 s80, s80, 49152
    s_waitcnt lgkmcnt(12)
    v_mfma_f32_16x16x32_bf16 v[144:147], a[244:247], a[140:143], v[144:147]
    ds_read_b64_tr_b16 a[232:233], v18 offset:26624
    v_mfma_f32_16x16x32_bf16 v[128:131], a[244:247], a[136:139], v[128:131]
    ds_read_b64_tr_b16 a[234:235], v18 offset:27136
    s_add_u32 s49, s49, s52
    v_mfma_f32_16x16x32_bf16 v[112:115], a[244:247], a[132:135], v[112:115]
    ds_read_b64_tr_b16 a[236:237], v19 offset:26624
    v_mfma_f32_16x16x32_bf16 v[96:99], a[244:247], a[128:131], v[96:99]
    ds_read_b64_tr_b16 a[238:239], v19 offset:27136
    s_waitcnt lgkmcnt(13)
    v_mfma_f32_16x16x32_bf16 v[52:55], a[248:251], a[144:147], v[52:55]
    buffer_load_dwordx4 v6, s[16:19], s50 offen offset:0 lds
    s_waitcnt lgkmcnt(12)
    v_mfma_f32_16x16x32_bf16 v[60:63], a[248:251], a[148:151], v[60:63]
    s_lshl_b32 s81, s44, 14
    s_add_u32 s81, s81, 98304
    s_waitcnt lgkmcnt(9)
    v_mfma_f32_16x16x32_bf16 v[68:71], a[248:251], a[152:155], v[68:71]
    s_waitcnt lgkmcnt(8)
    v_mfma_f32_16x16x32_bf16 v[76:79], a[248:251], a[156:159], v[76:79]
    buffer_load_dwordx4 v7, s[16:19], s50 offen offset:1024 lds
    v_mfma_f32_16x16x32_bf16 v[80:83], a[252:255], a[156:159], v[80:83]
    s_waitcnt vmcnt(8) lgkmcnt(0)
    s_barrier
    ds_read_b64_tr_b16 a[240:241], v18 offset:49152
    v_mfma_f32_16x16x32_bf16 v[72:75], a[252:255], a[152:155], v[72:75]
    ds_read_b64_tr_b16 a[242:243], v18 offset:49664
    v_mfma_f32_16x16x32_bf16 v[64:67], a[252:255], a[148:151], v[64:67]
    ds_read_b128 a[160:163], v12 offset:40960
    s_add_u32 m0, s53, 90112
    v_mfma_f32_16x16x32_bf16 v[56:59], a[252:255], a[144:147], v[56:59]
    ds_read_b128 a[164:167], v12 offset:43008
    v_mfma_f32_16x16x32_bf16 v[84:87], a[224:227], a[144:147], v[84:87]
    ds_read_b64_tr_b16 a[244:245], v19 offset:49152
    s_add_u32 s50, s50, s52
    v_mfma_f32_16x16x32_bf16 v[100:103], a[224:227], a[148:151], v[100:103]
    ds_read_b64_tr_b16 a[246:247], v19 offset:49664
    v_mfma_f32_16x16x32_bf16 v[116:119], a[224:227], a[152:155], v[116:119]
    ds_read_b128 a[168:171], v12 offset:51200
    v_mfma_f32_16x16x32_bf16 v[132:135], a[224:227], a[156:159], v[132:135]
    ds_read_b128 a[172:175], v12 offset:53248
    buffer_load_dwordx4 v8, s[20:23], s51 offen offset:0 lds
    v_mfma_f32_16x16x32_bf16 v[136:139], a[228:231], a[156:159], v[136:139]
    ds_read_b64_tr_b16 a[248:249], v18 offset:45056
    v_mfma_f32_16x16x32_bf16 v[120:123], a[228:231], a[152:155], v[120:123]
    ds_read_b64_tr_b16 a[250:251], v18 offset:45568
    v_mfma_f32_16x16x32_bf16 v[104:107], a[228:231], a[148:151], v[104:107]
    buffer_load_dwordx4 v9, s[20:23], s51 offen offset:1024 lds
    v_mfma_f32_16x16x32_bf16 v[88:91], a[228:231], a[144:147], v[88:91]
    v_mfma_f32_16x16x32_bf16 v[92:95], a[232:235], a[144:147], v[92:95]
    ds_read_b64_tr_b16 a[252:253], v19 offset:45056
    s_add_u32 s51, s51, 172032
    v_mfma_f32_16x16x32_bf16 v[108:111], a[232:235], a[148:151], v[108:111]
    ds_read_b64_tr_b16 a[254:255], v19 offset:45568
    v_lshrrev_b32_e64 v33, 3, v0
    v_and_b32_e64 v34, 2, v33
    v_lshlrev_b32_e64 v34, 1, v34
    v_and_b32_e64 v35, 7, v0
    v_xor_b32_e64 v34, v34, v35
    v_mfma_f32_16x16x32_bf16 v[124:127], a[232:235], a[152:155], v[124:127]
    v_mul_u32_u24 v33, 0x380, v33
    v_lshl_add_u32 v247, v34, 4, v33
    v_add_u32 v248, 6144, v247
    v_mfma_f32_16x16x32_bf16 v[140:143], a[232:235], a[156:159], v[140:143]
    v_bfe_u32 v33, v0, 2, 2
    v_lshrrev_b32_e64 v34, 5, v0
    v_mfma_f32_16x16x32_bf16 v[144:147], a[236:239], a[156:159], v[144:147]
    ds_read_b64_tr_b16 a[224:225], v18 offset:47104
    v_mfma_f32_16x16x32_bf16 v[128:131], a[236:239], a[152:155], v[128:131]
    ds_read_b64_tr_b16 a[226:227], v18 offset:47616
    v_mfma_f32_16x16x32_bf16 v[112:115], a[236:239], a[148:151], v[112:115]
    v_mfma_f32_16x16x32_bf16 v[96:99], a[236:239], a[144:147], v[96:99]
    s_waitcnt lgkmcnt(11)
    v_mfma_f32_16x16x32_bf16 v[52:55], a[240:243], a[160:163], v[52:55]
    ds_read_b64_tr_b16 a[228:229], v19 offset:47104
    s_add_u32 m0, s54, 122880
    s_waitcnt lgkmcnt(11)
    v_mfma_f32_16x16x32_bf16 v[60:63], a[240:243], a[164:167], v[60:63]
    ds_read_b64_tr_b16 a[230:231], v19 offset:47616
    s_cmp_lg_u32 s47, 0
    s_cselect_b32 s18, 0, s18
    s_waitcnt lgkmcnt(9)
    v_mfma_f32_16x16x32_bf16 v[68:71], a[240:243], a[168:171], v[68:71]
    buffer_load_dwordx4 v6, s[12:15], s55 offen offset:0 lds
    s_waitcnt lgkmcnt(8)
    v_mfma_f32_16x16x32_bf16 v[76:79], a[240:243], a[172:175], v[76:79]
    buffer_load_dwordx4 v7, s[12:15], s55 offen offset:1024 lds
    v_mfma_f32_16x16x32_bf16 v[80:83], a[244:247], a[172:175], v[80:83]
    ds_read_b64_tr_b16 a[232:233], v20 offset:4096
    v_mfma_f32_16x16x32_bf16 v[72:75], a[244:247], a[168:171], v[72:75]
    ds_read_b64_tr_b16 a[234:235], v20 offset:4608
    v_mfma_f32_16x16x32_bf16 v[64:67], a[244:247], a[164:167], v[64:67]
    ds_read_b128 a[176:179], v13 offset:40960
    s_add_u32 m0, s54, 124928
    v_mfma_f32_16x16x32_bf16 v[56:59], a[244:247], a[160:163], v[56:59]
    ds_read_b128 a[180:183], v13 offset:43008
    s_waitcnt lgkmcnt(10)
    v_mfma_f32_16x16x32_bf16 v[84:87], a[248:251], a[160:163], v[84:87]
    ds_read_b64_tr_b16 a[236:237], v21 offset:4096
    s_add_u32 s55, s55, s52
    v_mfma_f32_16x16x32_bf16 v[100:103], a[248:251], a[164:167], v[100:103]
    ds_read_b64_tr_b16 a[238:239], v21 offset:4608
    v_mfma_f32_16x16x32_bf16 v[116:119], a[248:251], a[168:171], v[116:119]
    ds_read_b128 a[184:187], v13 offset:51200
    v_and_b32_e64 v35, 1, v0
    v_lshlrev_b32_e64 v35, 4, v35
    v_bfe_u32 v36, v0, 1, 1
    v_lshl_add_u32 v35, v36, 3, v35
    v_mfma_f32_16x16x32_bf16 v[132:135], a[248:251], a[172:175], v[132:135]
    ds_read_b128 a[188:191], v13 offset:53248
    buffer_load_dwordx4 v6, s[16:19], s56 offen offset:0 lds
    s_waitcnt lgkmcnt(12)
    v_mfma_f32_16x16x32_bf16 v[136:139], a[252:255], a[172:175], v[136:139]
    ds_read_b64_tr_b16 a[240:241], v20 offset:0
    v_bfe_u32 v36, v0, 4, 1
    v_and_b32_e32 v37, 2, v33
    v_xor_b32_e64 v36, v36, v37
    v_mfma_f32_16x16x32_bf16 v[120:123], a[252:255], a[168:171], v[120:123]
    ds_read_b64_tr_b16 a[242:243], v20 offset:512
    v_lshl_add_u32 v35, v36, 5, v35
    v_lshl_add_u32 v35, v33, 7, v35
    v_mfma_f32_16x16x32_bf16 v[104:107], a[252:255], a[164:167], v[104:107]
    buffer_load_dwordx4 v7, s[16:19], s56 offen offset:1024 lds
    v_mfma_f32_16x16x32_bf16 v[88:91], a[252:255], a[160:163], v[88:91]
    v_lshl_add_u32 v36, v34, 10, v35
    v_add_u32_e64 v249, s80, v36
    v_xor_b32_e64 v250, 64, v249
    s_waitcnt lgkmcnt(12)
    v_mfma_f32_16x16x32_bf16 v[92:95], a[224:227], a[160:163], v[92:95]
    ds_read_b64_tr_b16 a[244:245], v21 offset:0
    s_add_u32 s56, s56, s52
    v_mfma_f32_16x16x32_bf16 v[108:111], a[224:227], a[164:167], v[108:111]
    ds_read_b64_tr_b16 a[246:247], v21 offset:512
    v_mfma_f32_16x16x32_bf16 v[124:127], a[224:227], a[168:171], v[124:127]
    v_mfma_f32_16x16x32_bf16 v[140:143], a[224:227], a[172:175], v[140:143]
    s_add_u32 m0, s54, 139264
    s_waitcnt lgkmcnt(12)
    v_mfma_f32_16x16x32_bf16 v[144:147], a[228:231], a[172:175], v[144:147]
    ds_read_b64_tr_b16 a[248:249], v20 offset:2048
    v_add_u32_e32 v251, s81, v36
    v_xor_b32_e64 v252, 64, v251
    v_mfma_f32_16x16x32_bf16 v[128:131], a[228:231], a[168:171], v[128:131]
    ds_read_b64_tr_b16 a[250:251], v20 offset:2560
    v_mfma_f32_16x16x32_bf16 v[112:115], a[228:231], a[164:167], v[112:115]
    ds_read_b64_tr_b16 a[252:253], v21 offset:2048
    buffer_load_dwordx4 v6, s[12:15], s55 offen offset:0 lds
    v_mfma_f32_16x16x32_bf16 v[96:99], a[228:231], a[160:163], v[96:99]
    ds_read_b64_tr_b16 a[254:255], v21 offset:2560
    s_waitcnt lgkmcnt(13)
    v_mfma_f32_16x16x32_bf16 v[52:55], a[232:235], a[176:179], v[52:55]
    buffer_load_dwordx4 v7, s[12:15], s55 offen offset:1024 lds
    s_waitcnt lgkmcnt(12)
    v_mfma_f32_16x16x32_bf16 v[60:63], a[232:235], a[180:183], v[60:63]
    s_waitcnt lgkmcnt(9)
    v_mfma_f32_16x16x32_bf16 v[68:71], a[232:235], a[184:187], v[68:71]
    v_lshlrev_b32_e32 v253, 9, v34
    s_waitcnt lgkmcnt(8)
    v_mfma_f32_16x16x32_bf16 v[76:79], a[232:235], a[188:191], v[76:79]
    s_add_u32 m0, s54, 141312
    v_mfma_f32_16x16x32_bf16 v[80:83], a[236:239], a[188:191], v[80:83]
    s_waitcnt vmcnt(6) lgkmcnt(0)
    s_barrier
    ds_read_b64_tr_b16 a[224:225], v20 offset:24576
    v_mfma_f32_16x16x32_bf16 v[72:75], a[236:239], a[184:187], v[72:75]
    ds_read_b64_tr_b16 a[226:227], v20 offset:25088
    v_mfma_f32_16x16x32_bf16 v[64:67], a[236:239], a[180:183], v[64:67]
    ds_read_b128 a[192:195], v14 offset:16384
    s_add_u32 s55, s55, s52
    v_mfma_f32_16x16x32_bf16 v[56:59], a[236:239], a[176:179], v[56:59]
    ds_read_b128 a[196:199], v14 offset:18432
    v_mfma_f32_16x16x32_bf16 v[84:87], a[240:243], a[176:179], v[84:87]
    ds_read_b64_tr_b16 a[228:229], v21 offset:24576
    buffer_load_dwordx4 v6, s[16:19], s56 offen offset:0 lds
    v_mfma_f32_16x16x32_bf16 v[100:103], a[240:243], a[180:183], v[100:103]
    ds_read_b64_tr_b16 a[230:231], v21 offset:25088
    v_mfma_f32_16x16x32_bf16 v[116:119], a[240:243], a[184:187], v[116:119]
    ds_read_b128 a[200:203], v14 offset:26624
    v_mfma_f32_16x16x32_bf16 v[132:135], a[240:243], a[188:191], v[132:135]
    ds_read_b128 a[204:207], v14 offset:28672
    buffer_load_dwordx4 v7, s[16:19], s56 offen offset:1024 lds
    v_mfma_f32_16x16x32_bf16 v[136:139], a[244:247], a[188:191], v[136:139]
    ds_read_b64_tr_b16 a[232:233], v20 offset:20480
    v_mfma_f32_16x16x32_bf16 v[120:123], a[244:247], a[184:187], v[120:123]
    ds_read_b64_tr_b16 a[234:235], v20 offset:20992
    v_mfma_f32_16x16x32_bf16 v[104:107], a[244:247], a[180:183], v[104:107]
    s_add_u32 s56, s56, s52
    v_mfma_f32_16x16x32_bf16 v[88:91], a[244:247], a[176:179], v[88:91]
    s_mul_i32 s92, s87, 294912
    s_add_u32 s92, s92, 6291456
    s_mul_i32 s88, s44, 28672
    s_add_u32 s78, s88, s92
    v_mfma_f32_16x16x32_bf16 v[92:95], a[248:251], a[176:179], v[92:95]
    ds_read_b64_tr_b16 a[236:237], v21 offset:20480
    s_lshl_b32 s88, s44, 13
    s_add_u32 s88, s88, s92
    s_add_u32 s1, s88, 114688
    v_mfma_f32_16x16x32_bf16 v[108:111], a[248:251], a[180:183], v[108:111]
    ds_read_b64_tr_b16 a[238:239], v21 offset:20992
    v_mfma_f32_16x16x32_bf16 v[124:127], a[248:251], a[184:187], v[124:127]
    v_add_u32 v254, 147456, v1
    v_mfma_f32_16x16x32_bf16 v[140:143], a[248:251], a[188:191], v[140:143]
    v_mfma_f32_16x16x32_bf16 v[144:147], a[252:255], a[188:191], v[144:147]
    ds_read_b64_tr_b16 a[240:241], v20 offset:22528
    v_mfma_f32_16x16x32_bf16 v[128:131], a[252:255], a[184:187], v[128:131]
    ds_read_b64_tr_b16 a[242:243], v20 offset:23040
    v_mfma_f32_16x16x32_bf16 v[112:115], a[252:255], a[180:183], v[112:115]
    v_mfma_f32_16x16x32_bf16 v[96:99], a[252:255], a[176:179], v[96:99]
    s_waitcnt lgkmcnt(11)
    v_mfma_f32_16x16x32_bf16 v[52:55], a[224:227], a[192:195], v[52:55]
    ds_read_b64_tr_b16 a[244:245], v21 offset:22528
    s_add_u32 m0, s54, 0
    s_waitcnt lgkmcnt(11)
    v_mfma_f32_16x16x32_bf16 v[60:63], a[224:227], a[196:199], v[60:63]
    ds_read_b64_tr_b16 a[246:247], v21 offset:23040
    buffer_load_dwordx4 v6, s[12:15], s55 offen offset:0 lds
    s_waitcnt lgkmcnt(9)
    v_mfma_f32_16x16x32_bf16 v[68:71], a[224:227], a[200:203], v[68:71]
    buffer_load_dwordx4 v7, s[12:15], s55 offen offset:1024 lds
    s_add_u32 m0, s54, 2048
    s_waitcnt lgkmcnt(8)
    v_mfma_f32_16x16x32_bf16 v[76:79], a[224:227], a[204:207], v[76:79]
    s_add_u32 s55, s55, s52
    v_mfma_f32_16x16x32_bf16 v[80:83], a[228:231], a[204:207], v[80:83]
    ds_read_b64_tr_b16 a[248:249], v20 offset:45056
    v_mfma_f32_16x16x32_bf16 v[72:75], a[228:231], a[200:203], v[72:75]
    ds_read_b64_tr_b16 a[250:251], v20 offset:45568
    v_mfma_f32_16x16x32_bf16 v[64:67], a[228:231], a[196:199], v[64:67]
    ds_read_b128 a[208:211], v15 offset:16384
    buffer_load_dwordx4 v6, s[16:19], s56 offen offset:0 lds
    v_mfma_f32_16x16x32_bf16 v[56:59], a[228:231], a[192:195], v[56:59]
    ds_read_b128 a[212:215], v15 offset:18432
    s_waitcnt lgkmcnt(10)
    v_mfma_f32_16x16x32_bf16 v[84:87], a[232:235], a[192:195], v[84:87]
    ds_read_b64_tr_b16 a[252:253], v21 offset:45056
    buffer_load_dwordx4 v7, s[16:19], s56 offen offset:1024 lds
    v_mfma_f32_16x16x32_bf16 v[100:103], a[232:235], a[196:199], v[100:103]
    ds_read_b64_tr_b16 a[254:255], v21 offset:45568
    v_mfma_f32_16x16x32_bf16 v[116:119], a[232:235], a[200:203], v[116:119]
    ds_read_b128 a[216:219], v15 offset:26624
    v_mfma_f32_16x16x32_bf16 v[132:135], a[232:235], a[204:207], v[132:135]
    ds_read_b128 a[220:223], v15 offset:28672
    s_add_u32 s56, s56, s52
    s_lshl_b32 s92, s87, 3
    s_add_u32 s92, s92, s44
    s_mul_i32 s92, s92, 7168
    s_add_u32 s82, s92, s89
    s_waitcnt lgkmcnt(12)
    v_mfma_f32_16x16x32_bf16 v[136:139], a[236:239], a[204:207], v[136:139]
    ds_read_b64_tr_b16 a[224:225], v20 offset:40960
    s_lshl_b32 s92, s87, 8
    s_add_u32 s83, s92, 15728640
    v_mfma_f32_16x16x32_bf16 v[120:123], a[236:239], a[200:203], v[120:123]
    ds_read_b64_tr_b16 a[226:227], v20 offset:41472
    s_lshr_b32 s87, s87, 1
    s_lshl_b32 s87, s87, 13
    s_add_u32 s87, s87, 16253056
    v_mfma_f32_16x16x32_bf16 v[104:107], a[236:239], a[196:199], v[104:107]
    s_add_u32 m0, s54, 16384
    v_mfma_f32_16x16x32_bf16 v[88:91], a[236:239], a[192:195], v[88:91]
    s_waitcnt lgkmcnt(12)
    v_mfma_f32_16x16x32_bf16 v[92:95], a[240:243], a[192:195], v[92:95]
    ds_read_b64_tr_b16 a[228:229], v21 offset:40960
    buffer_load_dwordx4 v6, s[12:15], s55 offen offset:0 lds
    v_mfma_f32_16x16x32_bf16 v[108:111], a[240:243], a[196:199], v[108:111]
    ds_read_b64_tr_b16 a[230:231], v21 offset:41472
    s_lshl_b32 s88, s45, 13
    s_add_u32 s88, s88, 16260224
    v_mfma_f32_16x16x32_bf16 v[124:127], a[240:243], a[200:203], v[124:127]
    v_mfma_f32_16x16x32_bf16 v[140:143], a[240:243], a[204:207], v[140:143]
    buffer_load_dwordx4 v7, s[12:15], s55 offen offset:1024 lds
    s_waitcnt lgkmcnt(12)
    v_mfma_f32_16x16x32_bf16 v[144:147], a[244:247], a[204:207], v[144:147]
    ds_read_b64_tr_b16 a[232:233], v20 offset:43008
    v_mfma_f32_16x16x32_bf16 v[128:131], a[244:247], a[200:203], v[128:131]
    ds_read_b64_tr_b16 a[234:235], v20 offset:43520
    v_mfma_f32_16x16x32_bf16 v[112:115], a[244:247], a[196:199], v[112:115]
    ds_read_b64_tr_b16 a[236:237], v21 offset:43008
    s_add_u32 m0, s54, 18432
    v_mfma_f32_16x16x32_bf16 v[96:99], a[244:247], a[192:195], v[96:99]
    ds_read_b64_tr_b16 a[238:239], v21 offset:43520
    s_waitcnt lgkmcnt(13)
    v_mfma_f32_16x16x32_bf16 v[52:55], a[248:251], a[208:211], v[52:55]
    s_add_u32 s55, s55, s52
    s_waitcnt lgkmcnt(12)
    v_mfma_f32_16x16x32_bf16 v[60:63], a[248:251], a[212:215], v[60:63]
    s_waitcnt lgkmcnt(9)
    v_mfma_f32_16x16x32_bf16 v[68:71], a[248:251], a[216:219], v[68:71]
    s_waitcnt lgkmcnt(8)
    v_mfma_f32_16x16x32_bf16 v[76:79], a[248:251], a[220:223], v[76:79]
    buffer_load_dwordx4 v6, s[16:19], s56 offen offset:0 lds
    v_mfma_f32_16x16x32_bf16 v[80:83], a[252:255], a[220:223], v[80:83]
    s_waitcnt vmcnt(7) lgkmcnt(0)
    s_barrier
    ds_read_b64_tr_b16 a[240:241], v26 offset:57344
    v_mfma_f32_16x16x32_bf16 v[72:75], a[252:255], a[216:219], v[72:75]
    ds_read_b64_tr_b16 a[242:243], v26 offset:57856
    v_mfma_f32_16x16x32_bf16 v[64:67], a[252:255], a[212:215], v[64:67]
    buffer_load_dwordx4 v7, s[16:19], s56 offen offset:1024 lds
    v_mfma_f32_16x16x32_bf16 v[56:59], a[252:255], a[208:211], v[56:59]
    v_mfma_f32_16x16x32_bf16 v[84:87], a[224:227], a[208:211], v[84:87]
    ds_read_b64_tr_b16 a[244:245], v27 offset:57344
    s_add_u32 s56, s56, s52
    v_lshlrev_b32_e64 v33, 9, v0
    v_add_u32_e64 v33, s87, v33
    v_mov_b32_e64 v34, s88
    v_cmp_gt_u32 vcc, 16, v0
    s_nop 1
    v_cndmask_b32 v246, v34, v33, vcc
    v_mfma_f32_16x16x32_bf16 v[100:103], a[224:227], a[212:215], v[100:103]
    ds_read_b64_tr_b16 a[246:247], v27 offset:57856
    v_mfma_f32_16x16x32_bf16 v[116:119], a[224:227], a[216:219], v[116:119]
    v_mfma_f32_16x16x32_bf16 v[132:135], a[224:227], a[220:223], v[132:135]
    v_mfma_f32_16x16x32_bf16 v[136:139], a[228:231], a[220:223], v[136:139]
    ds_read_b64_tr_b16 a[248:249], v26 offset:59392
    v_mfma_f32_16x16x32_bf16 v[120:123], a[228:231], a[216:219], v[120:123]
    ds_read_b64_tr_b16 a[250:251], v26 offset:59904
    v_mfma_f32_16x16x32_bf16 v[104:107], a[228:231], a[212:215], v[104:107]
    v_mfma_f32_16x16x32_bf16 v[88:91], a[228:231], a[208:211], v[88:91]
    v_mfma_f32_16x16x32_bf16 v[92:95], a[232:235], a[208:211], v[92:95]
    ds_read_b64_tr_b16 a[252:253], v27 offset:59392
    v_mfma_f32_16x16x32_bf16 v[108:111], a[232:235], a[212:215], v[108:111]
    ds_read_b64_tr_b16 a[254:255], v27 offset:59904
    v_mfma_f32_16x16x32_bf16 v[124:127], a[232:235], a[216:219], v[124:127]
    v_mfma_f32_16x16x32_bf16 v[140:143], a[232:235], a[220:223], v[140:143]
    v_mfma_f32_16x16x32_bf16 v[144:147], a[236:239], a[220:223], v[144:147]
    ds_read_b64_tr_b16 a[224:225], v28 offset:0
    v_mfma_f32_16x16x32_bf16 v[128:131], a[236:239], a[216:219], v[128:131]
    ds_read_b64_tr_b16 a[226:227], v28 offset:512
    v_mfma_f32_16x16x32_bf16 v[112:115], a[236:239], a[212:215], v[112:115]
    v_mfma_f32_16x16x32_bf16 v[96:99], a[236:239], a[208:211], v[96:99]
    s_cmp_lg_u32 s76, 0
    s_cselect_b32 s30, s30, 0
    s_cselect_b32 s34, s34, 0
    s_cselect_b32 s10, s26, 0
    s_mov_b32 s8, s24
    s_mov_b32 s9, s25
    s_cmp_lg_u32 s47, 0
    s_cbranch_scc1 L_vpath
    s_waitcnt lgkmcnt(8)
    v_mfma_f32_16x16x32_bf16 v[148:151], a[240:243], a[0:3], 0
    ds_read_b64_tr_b16 a[228:229], v29 offset:0
    v_mfma_f32_16x16x32_bf16 v[164:167], a[240:243], a[4:7], 0
    ds_read_b64_tr_b16 a[230:231], v29 offset:512
    v_mfma_f32_16x16x32_bf16 v[180:183], a[240:243], a[8:11], 0
    v_mfma_f32_16x16x32_bf16 v[196:199], a[240:243], a[12:15], 0
    v_cvt_pk_bf16_f32 v52, v52, v53
    v_cvt_pk_bf16_f32 v53, v54, v55
    s_waitcnt lgkmcnt(8)
    v_mfma_f32_16x16x32_bf16 v[200:203], a[244:247], a[12:15], 0
    ds_read_b64_tr_b16 a[232:233], v28 offset:2048
    v_cvt_pk_bf16_f32 v54, v56, v57
    v_cvt_pk_bf16_f32 v55, v58, v59
    v_mfma_f32_16x16x32_bf16 v[184:187], a[244:247], a[8:11], 0
    ds_read_b64_tr_b16 a[234:235], v28 offset:2560
    v_permlane32_swap_b32 v52, v54
    v_permlane32_swap_b32 v53, v55
    v_mfma_f32_16x16x32_bf16 v[168:171], a[244:247], a[4:7], 0
    v_permlane16_swap_b32 v52, v54
    v_permlane16_swap_b32 v53, v55
    v_mfma_f32_16x16x32_bf16 v[152:155], a[244:247], a[0:3], 0
    s_waitcnt lgkmcnt(8)
    v_mfma_f32_16x16x32_bf16 v[156:159], a[248:251], a[0:3], 0
    ds_read_b64_tr_b16 a[236:237], v29 offset:2048
    s_add_u32 m0, s54, 49152
    v_mfma_f32_16x16x32_bf16 v[172:175], a[248:251], a[4:7], 0
    ds_read_b64_tr_b16 a[238:239], v29 offset:2560
    v_mfma_f32_16x16x32_bf16 v[188:191], a[248:251], a[8:11], 0
    buffer_load_dwordx4 v6, s[12:15], s55 offen offset:0 lds
    v_mfma_f32_16x16x32_bf16 v[204:207], a[248:251], a[12:15], 0
    s_waitcnt lgkmcnt(8)
    v_mfma_f32_16x16x32_bf16 v[208:211], a[252:255], a[12:15], 0
    ds_read_b64_tr_b16 a[240:241], v28 offset:8192
    v_mfma_f32_16x16x32_bf16 v[192:195], a[252:255], a[8:11], 0
    ds_read_b64_tr_b16 a[242:243], v28 offset:8704
    buffer_load_dwordx4 v7, s[12:15], s55 offen offset:1024 lds
    v_mfma_f32_16x16x32_bf16 v[176:179], a[252:255], a[4:7], 0
    buffer_store_dwordx4 v[52:55], v10, s[24:27], s58 offen offset:0 sc1
    v_mfma_f32_16x16x32_bf16 v[160:163], a[252:255], a[0:3], 0
    s_add_u32 m0, s54, 51200
    v_cvt_pk_bf16_f32 v60, v60, v61
    s_waitcnt lgkmcnt(8)
    v_mfma_f32_16x16x32_bf16 v[148:151], a[224:227], a[16:19], v[148:151]
    ds_read_b64_tr_b16 a[244:245], v29 offset:8192
    v_cvt_pk_bf16_f32 v61, v62, v63
    v_cvt_pk_bf16_f32 v62, v64, v65
    v_mfma_f32_16x16x32_bf16 v[164:167], a[224:227], a[20:23], v[164:167]
    ds_read_b64_tr_b16 a[246:247], v29 offset:8704
    v_cvt_pk_bf16_f32 v63, v66, v67
    v_permlane32_swap_b32 v60, v62
    v_mfma_f32_16x16x32_bf16 v[180:183], a[224:227], a[24:27], v[180:183]
    s_add_u32 s55, s55, s52
    v_permlane32_swap_b32 v61, v63
    v_permlane16_swap_b32 v60, v62
    v_mfma_f32_16x16x32_bf16 v[196:199], a[224:227], a[28:31], v[196:199]
    v_permlane16_swap_b32 v61, v63
    s_waitcnt lgkmcnt(8)
    v_mfma_f32_16x16x32_bf16 v[200:203], a[228:231], a[28:31], v[200:203]
    ds_read_b64_tr_b16 a[248:249], v28 offset:10240
    buffer_load_dwordx4 v6, s[16:19], s56 offen offset:0 lds
    v_mfma_f32_16x16x32_bf16 v[184:187], a[228:231], a[24:27], v[184:187]
    ds_read_b64_tr_b16 a[250:251], v28 offset:10752
    v_mfma_f32_16x16x32_bf16 v[168:171], a[228:231], a[20:23], v[168:171]
    buffer_store_dwordx4 v[60:63], v10, s[24:27], s58 offen offset:256 sc1
    v_mfma_f32_16x16x32_bf16 v[152:155], a[228:231], a[16:19], v[152:155]
    buffer_load_dwordx4 v7, s[16:19], s56 offen offset:1024 lds
    s_waitcnt lgkmcnt(8)
    v_mfma_f32_16x16x32_bf16 v[156:159], a[232:235], a[16:19], v[156:159]
    ds_read_b64_tr_b16 a[252:253], v29 offset:10240
    v_cvt_pk_bf16_f32 v68, v68, v69
    v_cvt_pk_bf16_f32 v69, v70, v71
    v_mfma_f32_16x16x32_bf16 v[172:175], a[232:235], a[20:23], v[172:175]
    ds_read_b64_tr_b16 a[254:255], v29 offset:10752
    s_add_u32 s56, s56, s52
    v_cvt_pk_bf16_f32 v70, v72, v73
    v_mfma_f32_16x16x32_bf16 v[188:191], a[232:235], a[24:27], v[188:191]
    v_cvt_pk_bf16_f32 v71, v74, v75
    v_permlane32_swap_b32 v68, v70
    v_mfma_f32_16x16x32_bf16 v[204:207], a[232:235], a[28:31], v[204:207]
    v_permlane32_swap_b32 v69, v71
    v_permlane16_swap_b32 v68, v70
    s_waitcnt lgkmcnt(8)
    v_mfma_f32_16x16x32_bf16 v[208:211], a[236:239], a[28:31], v[208:211]
    ds_read_b64_tr_b16 a[224:225], v28 offset:16384
    s_add_u32 m0, s54, 65536
    v_permlane16_swap_b32 v69, v71
    v_mfma_f32_16x16x32_bf16 v[192:195], a[236:239], a[24:27], v[192:195]
    ds_read_b64_tr_b16 a[226:227], v28 offset:16896
    v_mfma_f32_16x16x32_bf16 v[176:179], a[236:239], a[20:23], v[176:179]
    v_readfirstlane_b32 s57, v48
    s_nop 1
    s_cmp_lg_u32 s57, 0
    s_cbranch_scc1 L_gottag2
    s_mov_b32 s84, 0
L_tagspin2:
    global_load_dword v48, v49, s[40:41] sc1
    s_add_u32 s84, s84, 1
    s_cmp_gt_u32 s84, 1048576
    s_cbranch_scc1 L_exit
    s_waitcnt vmcnt(0)
    v_readfirstlane_b32 s57, v48
    s_nop 1
    s_cmp_lg_u32 s57, 0
    s_cbranch_scc0 L_tagspin2
L_gottag2:
    v_mfma_f32_16x16x32_bf16 v[160:163], a[236:239], a[16:19], v[160:163]
    buffer_load_dwordx4 v6, s[12:15], s55 offen offset:0 lds
    s_waitcnt lgkmcnt(8)
    v_mfma_f32_16x16x32_bf16 v[148:151], a[240:243], a[32:35], v[148:151]
    ds_read_b64_tr_b16 a[228:229], v29 offset:16384
    buffer_store_dwordx4 v[68:71], v10, s[24:27], s59 offen offset:0 sc1
    v_mfma_f32_16x16x32_bf16 v[164:167], a[240:243], a[36:39], v[164:167]
    ds_read_b64_tr_b16 a[230:231], v29 offset:16896
    buffer_load_dwordx4 v7, s[12:15], s55 offen offset:1024 lds
    v_cvt_pk_bf16_f32 v76, v76, v77
    v_mfma_f32_16x16x32_bf16 v[180:183], a[240:243], a[40:43], v[180:183]
    v_cvt_pk_bf16_f32 v77, v78, v79
    v_cvt_pk_bf16_f32 v78, v80, v81
    v_cvt_pk_bf16_f32 v79, v82, v83
    v_mfma_f32_16x16x32_bf16 v[196:199], a[240:243], a[44:47], v[196:199]
    s_add_u32 m0, s54, 67584
    v_permlane32_swap_b32 v76, v78
    s_waitcnt lgkmcnt(8)
    v_mfma_f32_16x16x32_bf16 v[200:203], a[244:247], a[44:47], v[200:203]
    ds_read_b64_tr_b16 a[232:233], v28 offset:18432
    v_permlane32_swap_b32 v77, v79
    v_permlane16_swap_b32 v76, v78
    v_mfma_f32_16x16x32_bf16 v[184:187], a[244:247], a[40:43], v[184:187]
    ds_read_b64_tr_b16 a[234:235], v28 offset:18944
    v_permlane16_swap_b32 v77, v79
    v_mfma_f32_16x16x32_bf16 v[168:171], a[244:247], a[36:39], v[168:171]
    ds_read_b64_tr_b16 a[236:237], v29 offset:18432
    s_add_u32 s55, s55, s52
    v_mfma_f32_16x16x32_bf16 v[152:155], a[244:247], a[32:35], v[152:155]
    ds_read_b64_tr_b16 a[238:239], v29 offset:18944
    s_waitcnt lgkmcnt(10)
    v_mfma_f32_16x16x32_bf16 v[156:159], a[248:251], a[32:35], v[156:159]
    buffer_load_dwordx4 v6, s[16:19], s56 offen offset:0 lds
    buffer_store_dwordx4 v[76:79], v10, s[24:27], s59 offen offset:256 sc1
    v_mfma_f32_16x16x32_bf16 v[172:175], a[248:251], a[36:39], v[172:175]
    v_pk_mul_f32 v[84:85], v[84:85], s[62:63] op_sel_hi:[1,0]
    v_pk_mul_f32 v[86:87], v[86:87], s[62:63] op_sel_hi:[1,0]
    v_pk_mul_f32 v[88:89], v[88:89], s[62:63] op_sel_hi:[1,0]
    v_mfma_f32_16x16x32_bf16 v[188:191], a[248:251], a[40:43], v[188:191]
    v_pk_mul_f32 v[90:91], v[90:91], s[62:63] op_sel_hi:[1,0]
    v_exp_f32_e32 v84, v84
    v_mfma_f32_16x16x32_bf16 v[204:207], a[248:251], a[44:47], v[204:207]
    buffer_load_dwordx4 v7, s[16:19], s56 offen offset:1024 lds
    s_waitcnt lgkmcnt(8)
    v_mfma_f32_16x16x32_bf16 v[208:211], a[252:255], a[44:47], v[208:211]
    s_waitcnt vmcnt(12) lgkmcnt(0)
    s_barrier
    ds_read_b64_tr_b16 a[240:241], v24 offset:0
    v_mfma_f32_16x16x32_bf16 v[192:195], a[252:255], a[40:43], v[192:195]
    ds_read_b64_tr_b16 a[242:243], v24 offset:512
    s_add_u32 s56, s56, s52
    v_mfma_f32_16x16x32_bf16 v[176:179], a[252:255], a[36:39], v[176:179]
    v_exp_f32_e64 v85, v85
    v_mfma_f32_16x16x32_bf16 v[160:163], a[252:255], a[32:35], v[160:163]
    v_exp_f32_e64 v86, v86
    v_mfma_f32_16x16x32_bf16 v[148:151], a[224:227], a[48:51], v[148:151]
    ds_read_b64_tr_b16 a[244:245], v25 offset:0
    s_add_u32 m0, s54, 81920
    v_exp_f32_e64 v87, v87
    v_mfma_f32_16x16x32_bf16 v[164:167], a[224:227], a[52:55], v[164:167]
    ds_read_b64_tr_b16 a[246:247], v25 offset:512
    v_exp_f32_e64 v88, v88
    v_mfma_f32_16x16x32_bf16 v[180:183], a[224:227], a[56:59], v[180:183]
    buffer_load_dwordx4 v6, s[12:15], s55 offen offset:0 lds
    v_exp_f32_e64 v89, v89
    v_mfma_f32_16x16x32_bf16 v[196:199], a[224:227], a[60:63], v[196:199]
    v_exp_f32_e64 v90, v90
    v_mfma_f32_16x16x32_bf16 v[200:203], a[228:231], a[60:63], v[200:203]
    ds_read_b64_tr_b16 a[248:249], v24 offset:2048
    v_exp_f32_e64 v91, v91
    v_mfma_f32_16x16x32_bf16 v[184:187], a[228:231], a[56:59], v[184:187]
    ds_read_b64_tr_b16 a[250:251], v24 offset:2560
    buffer_load_dwordx4 v7, s[12:15], s55 offen offset:1024 lds
    v_pk_add_f32 v[84:85], v[84:85], 1.0 op_sel_hi:[1,0]
    v_mfma_f32_16x16x32_bf16 v[168:171], a[228:231], a[52:55], v[168:171]
    v_pk_add_f32 v[86:87], v[86:87], 1.0 op_sel_hi:[1,0]
    v_pk_add_f32 v[88:89], v[88:89], 1.0 op_sel_hi:[1,0]
    v_pk_add_f32 v[90:91], v[90:91], 1.0 op_sel_hi:[1,0]
    v_mfma_f32_16x16x32_bf16 v[152:155], a[228:231], a[48:51], v[152:155]
    s_add_u32 m0, s54, 83968
    v_rcp_f32_e64 v84, v84
    v_mfma_f32_16x16x32_bf16 v[156:159], a[232:235], a[48:51], v[156:159]
    ds_read_b64_tr_b16 a[252:253], v25 offset:2048
    v_rcp_f32_e64 v85, v85
    v_mfma_f32_16x16x32_bf16 v[172:175], a[232:235], a[52:55], v[172:175]
    ds_read_b64_tr_b16 a[254:255], v25 offset:2560
    v_rcp_f32_e64 v86, v86
    v_mfma_f32_16x16x32_bf16 v[188:191], a[232:235], a[56:59], v[188:191]
    s_add_u32 s55, s55, s52
    v_rcp_f32_e32 v87, v87
    v_mfma_f32_16x16x32_bf16 v[204:207], a[232:235], a[60:63], v[204:207]
    v_rcp_f32_e64 v88, v88
    v_mfma_f32_16x16x32_bf16 v[208:211], a[236:239], a[60:63], v[208:211]
    ds_read_b64_tr_b16 a[224:225], v24 offset:8192
    buffer_load_dwordx4 v6, s[16:19], s56 offen offset:0 lds
    v_mfma_f32_16x16x32_bf16 v[192:195], a[236:239], a[56:59], v[192:195]
    ds_read_b64_tr_b16 a[226:227], v24 offset:8704
    v_rcp_f32_e64 v89, v89
    v_mfma_f32_16x16x32_bf16 v[176:179], a[236:239], a[52:55], v[176:179]
    v_rcp_f32_e64 v90, v90
    v_mfma_f32_16x16x32_bf16 v[160:163], a[236:239], a[48:51], v[160:163]
    buffer_load_dwordx4 v7, s[16:19], s56 offen offset:1024 lds
    s_waitcnt lgkmcnt(8)
    v_mfma_f32_16x16x32_bf16 v[148:151], a[240:243], a[64:67], v[148:151]
    ds_read_b64_tr_b16 a[228:229], v25 offset:8192
    v_rcp_f32_e32 v91, v91
    v_mfma_f32_16x16x32_bf16 v[164:167], a[240:243], a[68:71], v[164:167]
    ds_read_b64_tr_b16 a[230:231], v25 offset:8704
    s_add_u32 s56, s56, s52
    v_pk_mul_f32 v[84:85], v[84:85], v[92:93]
    v_mfma_f32_16x16x32_bf16 v[180:183], a[240:243], a[72:75], v[180:183]
    v_pk_mul_f32 v[86:87], v[86:87], v[94:95]
    v_pk_mul_f32 v[88:89], v[88:89], v[96:97]
    v_pk_mul_f32 v[90:91], v[90:91], v[98:99]
    v_mfma_f32_16x16x32_bf16 v[196:199], a[240:243], a[76:79], v[196:199]
    v_cvt_pk_bf16_f32 v84, v84, v85
    v_cvt_pk_bf16_f32 v85, v86, v87
    s_waitcnt lgkmcnt(8)
    v_mfma_f32_16x16x32_bf16 v[200:203], a[244:247], a[76:79], v[200:203]
    ds_read_b64_tr_b16 a[232:233], v24 offset:10240
    v_cvt_pk_bf16_f32 v86, v88, v89
    v_cvt_pk_bf16_f32 v87, v90, v91
    v_mfma_f32_16x16x32_bf16 v[184:187], a[244:247], a[72:75], v[184:187]
    ds_read_b64_tr_b16 a[234:235], v24 offset:10752
    v_permlane32_swap_b32 v84, v86
    v_permlane32_swap_b32 v85, v87
    v_mfma_f32_16x16x32_bf16 v[168:171], a[244:247], a[68:71], v[168:171]
    v_permlane16_swap_b32 v84, v86
    v_permlane16_swap_b32 v85, v87
    v_pk_mul_f32 v[100:101], v[100:101], s[62:63] op_sel_hi:[1,0]
    v_mfma_f32_16x16x32_bf16 v[152:155], a[244:247], a[64:67], v[152:155]
    v_pk_mul_f32 v[102:103], v[102:103], s[62:63] op_sel_hi:[1,0]
    v_pk_mul_f32 v[104:105], v[104:105], s[62:63] op_sel_hi:[1,0]
    s_waitcnt lgkmcnt(8)
    v_mfma_f32_16x16x32_bf16 v[156:159], a[248:251], a[64:67], v[156:159]
    ds_read_b64_tr_b16 a[236:237], v25 offset:10240
    s_add_u32 m0, s81, 0
    v_pk_mul_f32 v[106:107], v[106:107], s[62:63] op_sel_hi:[1,0]
    v_mfma_f32_16x16x32_bf16 v[172:175], a[248:251], a[68:71], v[172:175]
    ds_read_b64_tr_b16 a[238:239], v25 offset:10752
    buffer_load_dwordx4 v247, s[28:31], s77 offen offset:0 lds
    v_mfma_f32_16x16x32_bf16 v[188:191], a[248:251], a[72:75], v[188:191]
    v_exp_f32_e64 v100, v100
    v_mfma_f32_16x16x32_bf16 v[204:207], a[248:251], a[76:79], v[204:207]
    buffer_load_dwordx4 v248, s[28:31], s77 offen offset:1024 lds
    s_waitcnt lgkmcnt(8)
    v_mfma_f32_16x16x32_bf16 v[208:211], a[252:255], a[76:79], v[208:211]
    ds_read_b64_tr_b16 a[240:241], v24 offset:16384
    v_exp_f32_e32 v101, v101
    v_mfma_f32_16x16x32_bf16 v[192:195], a[252:255], a[72:75], v[192:195]
    ds_read_b64_tr_b16 a[242:243], v24 offset:16896
    v_exp_f32_e64 v102, v102
    v_mfma_f32_16x16x32_bf16 v[176:179], a[252:255], a[68:71], v[176:179]
    s_add_u32 m0, s81, 2048
    s_add_u32 s77, s77, 14336
    v_mfma_f32_16x16x32_bf16 v[160:163], a[252:255], a[64:67], v[160:163]
    buffer_load_dwordx4 v247, s[28:31], s77 offen offset:0 lds
    s_waitcnt lgkmcnt(8)
    v_mfma_f32_16x16x32_bf16 v[148:151], a[224:227], a[80:83], v[148:151]
    ds_read_b64_tr_b16 a[244:245], v25 offset:16384
    v_exp_f32_e32 v103, v103
    v_mfma_f32_16x16x32_bf16 v[164:167], a[224:227], a[84:87], v[164:167]
    ds_read_b64_tr_b16 a[246:247], v25 offset:16896
    v_exp_f32_e64 v104, v104
    v_mfma_f32_16x16x32_bf16 v[180:183], a[224:227], a[88:91], v[180:183]
    buffer_load_dwordx4 v248, s[28:31], s77 offen offset:1024 lds
    v_mfma_f32_16x16x32_bf16 v[196:199], a[224:227], a[92:95], v[196:199]
    v_exp_f32_e64 v105, v105
    s_waitcnt lgkmcnt(8)
    v_mfma_f32_16x16x32_bf16 v[200:203], a[228:231], a[92:95], v[200:203]
    ds_read_b64_tr_b16 a[248:249], v24 offset:18432
    v_exp_f32_e32 v106, v106
    v_mfma_f32_16x16x32_bf16 v[184:187], a[228:231], a[88:91], v[184:187]
    ds_read_b64_tr_b16 a[250:251], v24 offset:18944
    v_exp_f32_e64 v107, v107
    v_mfma_f32_16x16x32_bf16 v[168:171], a[228:231], a[84:87], v[168:171]
    s_add_u32 m0, s81, 4096
    s_add_u32 s77, s77, 14336
    v_pk_add_f32 v[100:101], v[100:101], 1.0 op_sel_hi:[1,0]
    v_mfma_f32_16x16x32_bf16 v[152:155], a[228:231], a[80:83], v[152:155]
    buffer_load_dwordx4 v247, s[28:31], s77 offen offset:0 lds
    s_waitcnt lgkmcnt(8)
    v_mfma_f32_16x16x32_bf16 v[156:159], a[232:235], a[80:83], v[156:159]
    s_waitcnt vmcnt(10)
    s_barrier
    s_cmp_eq_u32 s44, 0
    s_cbranch_scc0 L_nofl3
    v_mov_b32_e32 v33, s57
    s_mov_b32 exec_hi, 0
    buffer_store_dword v33, v50, s[24:27], 0 offen offset:0 sc1
    s_mov_b64 exec, -1
L_nofl3:
    ds_read_b64_tr_b16 a[252:253], v25 offset:18432
    v_mfma_f32_16x16x32_bf16 v[172:175], a[232:235], a[84:87], v[172:175]
    ds_read_b64_tr_b16 a[254:255], v25 offset:18944
    buffer_load_dwordx4 v248, s[28:31], s77 offen offset:1024 lds
    v_pk_add_f32 v[102:103], v[102:103], 1.0 op_sel_hi:[1,0]
    v_mfma_f32_16x16x32_bf16 v[188:191], a[232:235], a[88:91], v[188:191]
    v_pk_add_f32 v[104:105], v[104:105], 1.0 op_sel_hi:[1,0]
    v_pk_add_f32 v[106:107], v[106:107], 1.0 op_sel_hi:[1,0]
    v_mfma_f32_16x16x32_bf16 v[204:207], a[232:235], a[92:95], v[204:207]
    v_rcp_f32_e64 v100, v100
    s_waitcnt lgkmcnt(8)
    v_mfma_f32_16x16x32_bf16 v[208:211], a[236:239], a[92:95], v[208:211]
    ds_read_b64_tr_b16 a[224:225], v24 offset:24576
    s_add_u32 m0, s81, 6144
    s_add_u32 s77, s77, 14336
    v_mfma_f32_16x16x32_bf16 v[192:195], a[236:239], a[88:91], v[192:195]
    ds_read_b64_tr_b16 a[226:227], v24 offset:25088
    buffer_load_dwordx4 v247, s[28:31], s77 offen offset:0 lds
    v_rcp_f32_e32 v101, v101
    v_mfma_f32_16x16x32_bf16 v[176:179], a[236:239], a[84:87], v[176:179]
    v_rcp_f32_e64 v102, v102
    v_mfma_f32_16x16x32_bf16 v[160:163], a[236:239], a[80:83], v[160:163]
    v_rcp_f32_e64 v103, v103
    s_waitcnt lgkmcnt(8)
    v_mfma_f32_16x16x32_bf16 v[148:151], a[240:243], a[96:99], v[148:151]
    ds_read_b64_tr_b16 a[228:229], v25 offset:24576
    buffer_load_dwordx4 v248, s[28:31], s77 offen offset:1024 lds
    v_rcp_f32_e32 v104, v104
    v_mfma_f32_16x16x32_bf16 v[164:167], a[240:243], a[100:103], v[164:167]
    ds_read_b64_tr_b16 a[230:231], v25 offset:25088
    v_rcp_f32_e64 v105, v105
    v_rcp_f32_e64 v106, v106
    v_mfma_f32_16x16x32_bf16 v[180:183], a[240:243], a[104:107], v[180:183]
    v_rcp_f32_e64 v107, v107
    v_pk_mul_f32 v[100:101], v[100:101], v[108:109]
    v_mfma_f32_16x16x32_bf16 v[196:199], a[240:243], a[108:111], v[196:199]
    s_add_u32 m0, s81, 8192
    s_add_u32 s77, s77, 14336
    s_waitcnt lgkmcnt(8)
    v_mfma_f32_16x16x32_bf16 v[200:203], a[244:247], a[108:111], v[200:203]
    ds_read_b64_tr_b16 a[232:233], v24 offset:26624
    buffer_load_dwordx4 v247, s[28:31], s77 offen offset:0 lds
    v_pk_mul_f32 v[102:103], v[102:103], v[110:111]
    v_mfma_f32_16x16x32_bf16 v[184:187], a[244:247], a[104:107], v[184:187]
    ds_read_b64_tr_b16 a[234:235], v24 offset:27136
    v_pk_mul_f32 v[104:105], v[104:105], v[112:113]
    v_pk_mul_f32 v[106:107], v[106:107], v[114:115]
    v_mfma_f32_16x16x32_bf16 v[168:171], a[244:247], a[100:103], v[168:171]
    ds_read_b64_tr_b16 a[236:237], v25 offset:26624
    buffer_load_dwordx4 v248, s[28:31], s77 offen offset:1024 lds
    v_mfma_f32_16x16x32_bf16 v[152:155], a[244:247], a[96:99], v[152:155]
    ds_read_b64_tr_b16 a[238:239], v25 offset:27136
    v_cvt_pk_bf16_f32 v100, v100, v101
    s_waitcnt lgkmcnt(10)
    v_mfma_f32_16x16x32_bf16 v[156:159], a[248:251], a[96:99], v[156:159]
    v_cvt_pk_bf16_f32 v101, v102, v103
    v_cvt_pk_bf16_f32 v102, v104, v105
    v_cvt_pk_bf16_f32 v103, v106, v107
    v_mfma_f32_16x16x32_bf16 v[172:175], a[248:251], a[100:103], v[172:175]
    v_permlane32_swap_b32 v100, v102
    v_permlane32_swap_b32 v101, v103
    v_mfma_f32_16x16x32_bf16 v[188:191], a[248:251], a[104:107], v[188:191]
    s_add_u32 m0, s81, 10240
    s_add_u32 s77, s77, 14336
    v_permlane16_swap_b32 v100, v102
    v_mfma_f32_16x16x32_bf16 v[204:207], a[248:251], a[108:111], v[204:207]
    buffer_load_dwordx4 v247, s[28:31], s77 offen offset:0 lds
    s_waitcnt lgkmcnt(8)
    v_mfma_f32_16x16x32_bf16 v[208:211], a[252:255], a[108:111], v[208:211]
    s_waitcnt vmcnt(11) lgkmcnt(0)
    s_barrier
    ds_read_b64_tr_b16 a[240:241], v24 offset:49152
    v_mfma_f32_16x16x32_bf16 v[192:195], a[252:255], a[104:107], v[192:195]
    ds_read_b64_tr_b16 a[242:243], v24 offset:49664
    buffer_load_dwordx4 v248, s[28:31], s77 offen offset:1024 lds
    v_mfma_f32_16x16x32_bf16 v[176:179], a[252:255], a[100:103], v[176:179]
    v_permlane16_swap_b32 v101, v103
    v_pk_mul_f32 v[116:117], v[116:117], s[62:63] op_sel_hi:[1,0]
    v_pk_mul_f32 v[118:119], v[118:119], s[62:63] op_sel_hi:[1,0]
    v_mfma_f32_16x16x32_bf16 v[160:163], a[252:255], a[96:99], v[160:163]
    v_pk_mul_f32 v[120:121], v[120:121], s[62:63] op_sel_hi:[1,0]
    v_pk_mul_f32 v[122:123], v[122:123], s[62:63] op_sel_hi:[1,0]
    v_mfma_f32_16x16x32_bf16 v[148:151], a[224:227], a[112:115], v[148:151]
    ds_read_b64_tr_b16 a[244:245], v25 offset:49152
    v_exp_f32_e32 v116, v116
    v_mfma_f32_16x16x32_bf16 v[164:167], a[224:227], a[116:119], v[164:167]
    ds_read_b64_tr_b16 a[246:247], v25 offset:49664
    s_add_u32 m0, s81, 12288
    s_add_u32 s77, s77, 14336
    v_mfma_f32_16x16x32_bf16 v[180:183], a[224:227], a[120:123], v[180:183]
    buffer_load_dwordx4 v247, s[28:31], s77 offen offset:0 lds
    v_mfma_f32_16x16x32_bf16 v[196:199], a[224:227], a[124:127], v[196:199]
    v_exp_f32_e64 v117, v117
    v_mfma_f32_16x16x32_bf16 v[200:203], a[228:231], a[124:127], v[200:203]
    ds_read_b64_tr_b16 a[248:249], v24 offset:51200
    v_exp_f32_e64 v118, v118
    v_mfma_f32_16x16x32_bf16 v[184:187], a[228:231], a[120:123], v[184:187]
    ds_read_b64_tr_b16 a[250:251], v24 offset:51712
    buffer_load_dwordx4 v248, s[28:31], s77 offen offset:1024 lds
    v_mfma_f32_16x16x32_bf16 v[168:171], a[228:231], a[116:119], v[168:171]
    v_exp_f32_e64 v119, v119
    v_mfma_f32_16x16x32_bf16 v[152:155], a[228:231], a[112:115], v[152:155]
    v_exp_f32_e64 v120, v120
    v_mfma_f32_16x16x32_bf16 v[156:159], a[232:235], a[112:115], v[156:159]
    ds_read_b64_tr_b16 a[252:253], v25 offset:51200
    v_exp_f32_e64 v121, v121
    v_mfma_f32_16x16x32_bf16 v[172:175], a[232:235], a[116:119], v[172:175]
    ds_read_b64_tr_b16 a[254:255], v25 offset:51712
    s_add_u32 m0, s81, 14336
    s_add_u32 s77, s77, 14336
    v_exp_f32_e64 v122, v122
    v_mfma_f32_16x16x32_bf16 v[188:191], a[232:235], a[120:123], v[188:191]
    buffer_load_dwordx4 v247, s[28:31], s77 offen offset:0 lds
    v_exp_f32_e64 v123, v123
    v_mfma_f32_16x16x32_bf16 v[204:207], a[232:235], a[124:127], v[204:207]
    v_pk_add_f32 v[116:117], v[116:117], 1.0 op_sel_hi:[1,0]
    v_pk_add_f32 v[118:119], v[118:119], 1.0 op_sel_hi:[1,0]
    v_pk_add_f32 v[120:121], v[120:121], 1.0 op_sel_hi:[1,0]
    v_mfma_f32_16x16x32_bf16 v[208:211], a[236:239], a[124:127], v[208:211]
    ds_read_b64_tr_b16 a[224:225], v24 offset:57344
    buffer_load_dwordx4 v248, s[28:31], s77 offen offset:1024 lds
    v_mfma_f32_16x16x32_bf16 v[192:195], a[236:239], a[120:123], v[192:195]
    ds_read_b64_tr_b16 a[226:227], v24 offset:57856
    s_waitcnt vmcnt(14)
    ds_read_b64_tr_b16 a[0:1], v251 offset:0
    v_mfma_f32_16x16x32_bf16 v[176:179], a[236:239], a[116:119], v[176:179]
    ds_read_b64_tr_b16 a[2:3], v251 offset:512
    ds_read_b64_tr_b16 a[4:5], v252 offset:0
    ds_read_b64_tr_b16 a[6:7], v252 offset:512
    v_pk_add_f32 v[122:123], v[122:123], 1.0 op_sel_hi:[1,0]
    v_mfma_f32_16x16x32_bf16 v[160:163], a[236:239], a[112:115], v[160:163]
    v_rcp_f32_e32 v116, v116
    s_waitcnt lgkmcnt(12)
    v_mfma_f32_16x16x32_bf16 v[148:151], a[240:243], a[128:131], v[148:151]
    ds_read_b64_tr_b16 a[228:229], v25 offset:57344
    v_rcp_f32_e32 v117, v117
    v_mfma_f32_16x16x32_bf16 v[164:167], a[240:243], a[132:135], v[164:167]
    ds_read_b64_tr_b16 a[230:231], v25 offset:57856
    v_rcp_f32_e64 v118, v118
    v_rcp_f32_e64 v119, v119
    v_mfma_f32_16x16x32_bf16 v[180:183], a[240:243], a[136:139], v[180:183]
    s_waitcnt vmcnt(12)
    ds_read_b64_tr_b16 a[8:9], v251 offset:2048
    ds_read_b64_tr_b16 a[10:11], v251 offset:2560
    v_rcp_f32_e32 v120, v120
    v_mfma_f32_16x16x32_bf16 v[196:199], a[240:243], a[140:143], v[196:199]
    ds_read_b64_tr_b16 a[12:13], v252 offset:2048
    ds_read_b64_tr_b16 a[14:15], v252 offset:2560
    v_rcp_f32_e64 v121, v121
    s_waitcnt lgkmcnt(15)
    v_mfma_f32_16x16x32_bf16 v[200:203], a[244:247], a[140:143], v[200:203]
    ds_read_b64_tr_b16 a[232:233], v24 offset:59392
    v_rcp_f32_e32 v122, v122
    v_mfma_f32_16x16x32_bf16 v[184:187], a[244:247], a[136:139], v[184:187]
    ds_read_b64_tr_b16 a[234:235], v24 offset:59904
    v_rcp_f32_e64 v123, v123
    v_mfma_f32_16x16x32_bf16 v[168:171], a[244:247], a[132:135], v[168:171]
    s_waitcnt lgkmcnt(8)
    s_add_u32 m0, s81, 0
    s_add_u32 s77, s77, 14336
    v_pk_mul_f32 v[116:117], v[116:117], v[124:125]
    v_mfma_f32_16x16x32_bf16 v[152:155], a[244:247], a[128:131], v[152:155]
    buffer_load_dwordx4 v247, s[28:31], s77 offen offset:0 lds
    v_pk_mul_f32 v[118:119], v[118:119], v[126:127]
    v_mfma_f32_16x16x32_bf16 v[156:159], a[248:251], a[128:131], v[156:159]
    ds_read_b64_tr_b16 a[236:237], v25 offset:59392
    buffer_load_dwordx4 v248, s[28:31], s77 offen offset:1024 lds
    v_pk_mul_f32 v[120:121], v[120:121], v[128:129]
    v_mfma_f32_16x16x32_bf16 v[172:175], a[248:251], a[132:135], v[172:175]
    ds_read_b64_tr_b16 a[238:239], v25 offset:59904
    s_waitcnt vmcnt(12)
    ds_read_b64_tr_b16 a[16:17], v251 offset:4096
    v_pk_mul_f32 v[122:123], v[122:123], v[130:131]
    v_mfma_f32_16x16x32_bf16 v[188:191], a[248:251], a[136:139], v[188:191]
    ds_read_b64_tr_b16 a[18:19], v251 offset:4608
    ds_read_b64_tr_b16 a[20:21], v252 offset:4096
    ds_read_b64_tr_b16 a[22:23], v252 offset:4608
    v_cvt_pk_bf16_f32 v116, v116, v117
    v_mfma_f32_16x16x32_bf16 v[204:207], a[248:251], a[140:143], v[204:207]
    s_waitcnt lgkmcnt(8)
    s_add_u32 m0, s81, 2048
    s_add_u32 s77, s77, 14336
    v_cvt_pk_bf16_f32 v117, v118, v119
    v_mfma_f32_16x16x32_bf16 v[208:211], a[252:255], a[140:143], v[208:211]
    ds_read_b64_tr_b16 a[240:241], v26 offset:0
    buffer_load_dwordx4 v247, s[28:31], s77 offen offset:0 lds
    v_cvt_pk_bf16_f32 v118, v120, v121
    v_mfma_f32_16x16x32_bf16 v[192:195], a[252:255], a[136:139], v[192:195]
    ds_read_b64_tr_b16 a[242:243], v26 offset:512
    buffer_load_dwordx4 v248, s[28:31], s77 offen offset:1024 lds
    v_cvt_pk_bf16_f32 v119, v122, v123
    v_mfma_f32_16x16x32_bf16 v[176:179], a[252:255], a[132:135], v[176:179]
    s_waitcnt lgkmcnt(2)
    s_add_u32 m0, s81, 4096
    s_add_u32 s77, s77, 14336
    v_permlane32_swap_b32 v116, v118
    v_mfma_f32_16x16x32_bf16 v[160:163], a[252:255], a[128:131], v[160:163]
    buffer_load_dwordx4 v247, s[28:31], s77 offen offset:0 lds
    v_permlane32_swap_b32 v117, v119
    v_mfma_f32_16x16x32_bf16 v[148:151], a[224:227], a[144:147], v[148:151]
    ds_read_b64_tr_b16 a[244:245], v27 offset:0
    buffer_load_dwordx4 v248, s[28:31], s77 offen offset:1024 lds
    v_permlane16_swap_b32 v116, v118
    v_mfma_f32_16x16x32_bf16 v[164:167], a[224:227], a[148:151], v[164:167]
    ds_read_b64_tr_b16 a[246:247], v27 offset:512
    s_waitcnt vmcnt(14)
    ds_read_b64_tr_b16 a[24:25], v251 offset:6144
    v_permlane16_swap_b32 v117, v119
    v_mfma_f32_16x16x32_bf16 v[180:183], a[224:227], a[152:155], v[180:183]
    ds_read_b64_tr_b16 a[26:27], v251 offset:6656
    ds_read_b64_tr_b16 a[28:29], v252 offset:6144
    ds_read_b64_tr_b16 a[30:31], v252 offset:6656
    v_pk_mul_f32 v[132:133], v[132:133], s[62:63] op_sel_hi:[1,0]
    v_mfma_f32_16x16x32_bf16 v[196:199], a[224:227], a[156:159], v[196:199]
    s_waitcnt lgkmcnt(0)
    s_add_u32 m0, s81, 6144
    s_add_u32 s77, s77, 14336
    v_pk_mul_f32 v[134:135], v[134:135], s[62:63] op_sel_hi:[1,0]
    v_mfma_f32_16x16x32_bf16 v[200:203], a[228:231], a[156:159], v[200:203]
    ds_read_b64_tr_b16 a[248:249], v26 offset:2048
    buffer_load_dwordx4 v247, s[28:31], s77 offen offset:0 lds
    v_pk_mul_f32 v[136:137], v[136:137], s[62:63] op_sel_hi:[1,0]
    v_mfma_f32_16x16x32_bf16 v[184:187], a[228:231], a[152:155], v[184:187]
    ds_read_b64_tr_b16 a[250:251], v26 offset:2560
    buffer_load_dwordx4 v248, s[28:31], s77 offen offset:1024 lds
    v_pk_mul_f32 v[138:139], v[138:139], s[62:63] op_sel_hi:[1,0]
    v_mfma_f32_16x16x32_bf16 v[168:171], a[228:231], a[148:151], v[168:171]
    s_waitcnt vmcnt(14)
    ds_read_b64_tr_b16 a[32:33], v251 offset:8192
    ds_read_b64_tr_b16 a[34:35], v251 offset:8704
    v_exp_f32_e64 v132, v132
    v_mfma_f32_16x16x32_bf16 v[152:155], a[228:231], a[144:147], v[152:155]
    ds_read_b64_tr_b16 a[36:37], v252 offset:8192
    ds_read_b64_tr_b16 a[38:39], v252 offset:8704
    v_exp_f32_e64 v133, v133
    v_mfma_f32_16x16x32_bf16 v[156:159], a[232:235], a[144:147], v[156:159]
    ds_read_b64_tr_b16 a[252:253], v27 offset:2048
    v_exp_f32_e64 v134, v134
    v_mfma_f32_16x16x32_bf16 v[172:175], a[232:235], a[148:151], v[172:175]
    ds_read_b64_tr_b16 a[254:255], v27 offset:2560
    v_exp_f32_e64 v135, v135
    v_mfma_f32_16x16x32_bf16 v[188:191], a[232:235], a[152:155], v[188:191]
    s_waitcnt lgkmcnt(2)
    s_add_u32 m0, s81, 8192
    s_add_u32 s77, s77, 14336
    v_exp_f32_e32 v136, v136
    v_mfma_f32_16x16x32_bf16 v[204:207], a[232:235], a[156:159], v[204:207]
    buffer_load_dwordx4 v247, s[28:31], s77 offen offset:0 lds
    v_exp_f32_e64 v137, v137
    v_mfma_f32_16x16x32_bf16 v[208:211], a[236:239], a[156:159], v[208:211]
    ds_read_b64_tr_b16 a[224:225], v26 offset:8192
    buffer_load_dwordx4 v248, s[28:31], s77 offen offset:1024 lds
    v_exp_f32_e64 v138, v138
    v_mfma_f32_16x16x32_bf16 v[192:195], a[236:239], a[152:155], v[192:195]
    ds_read_b64_tr_b16 a[226:227], v26 offset:8704
    s_waitcnt vmcnt(14)
    ds_read_b64_tr_b16 a[40:41], v251 offset:10240
    v_exp_f32_e32 v139, v139
    v_mfma_f32_16x16x32_bf16 v[176:179], a[236:239], a[148:151], v[176:179]
    ds_read_b64_tr_b16 a[42:43], v251 offset:10752
    ds_read_b64_tr_b16 a[44:45], v252 offset:10240
    ds_read_b64_tr_b16 a[46:47], v252 offset:10752
    v_pk_add_f32 v[132:133], v[132:133], 1.0 op_sel_hi:[1,0]
    v_mfma_f32_16x16x32_bf16 v[160:163], a[236:239], a[144:147], v[160:163]
    v_pk_add_f32 v[134:135], v[134:135], 1.0 op_sel_hi:[1,0]
    v_pk_add_f32 v[136:137], v[136:137], 1.0 op_sel_hi:[1,0]
    v_mfma_f32_16x16x32_bf16 v[148:151], a[240:243], a[160:163], v[148:151]
    ds_read_b64_tr_b16 a[228:229], v27 offset:8192
    v_pk_add_f32 v[138:139], v[138:139], 1.0 op_sel_hi:[1,0]
    v_mfma_f32_16x16x32_bf16 v[164:167], a[240:243], a[164:167], v[164:167]
    ds_read_b64_tr_b16 a[230:231], v27 offset:8704
    v_rcp_f32_e64 v132, v132
    v_mfma_f32_16x16x32_bf16 v[180:183], a[240:243], a[168:171], v[180:183]
    s_waitcnt vmcnt(12)
    ds_read_b64_tr_b16 a[48:49], v251 offset:12288
    ds_read_b64_tr_b16 a[50:51], v251 offset:12800
    v_rcp_f32_e32 v133, v133
    v_mfma_f32_16x16x32_bf16 v[196:199], a[240:243], a[172:175], v[196:199]
    ds_read_b64_tr_b16 a[52:53], v252 offset:12288
    ds_read_b64_tr_b16 a[54:55], v252 offset:12800
    v_rcp_f32_e64 v134, v134
    v_mfma_f32_16x16x32_bf16 v[200:203], a[244:247], a[172:175], v[200:203]
    ds_read_b64_tr_b16 a[232:233], v26 offset:10240
    v_rcp_f32_e64 v135, v135
    v_mfma_f32_16x16x32_bf16 v[184:187], a[244:247], a[168:171], v[184:187]
    ds_read_b64_tr_b16 a[234:235], v26 offset:10752
    v_rcp_f32_e64 v136, v136
    v_mfma_f32_16x16x32_bf16 v[168:171], a[244:247], a[164:167], v[168:171]
    s_waitcnt lgkmcnt(8)
    s_add_u32 m0, s81, 10240
    s_add_u32 s77, s77, 14336
    v_rcp_f32_e32 v137, v137
    v_mfma_f32_16x16x32_bf16 v[152:155], a[244:247], a[160:163], v[152:155]
    buffer_load_dwordx4 v247, s[28:31], s77 offen offset:0 lds
    v_rcp_f32_e64 v138, v138
    v_mfma_f32_16x16x32_bf16 v[156:159], a[248:251], a[160:163], v[156:159]
    ds_read_b64_tr_b16 a[236:237], v27 offset:10240
    buffer_load_dwordx4 v248, s[28:31], s77 offen offset:1024 lds
    v_rcp_f32_e64 v139, v139
    v_mfma_f32_16x16x32_bf16 v[172:175], a[248:251], a[164:167], v[172:175]
    ds_read_b64_tr_b16 a[238:239], v27 offset:10752
    s_waitcnt vmcnt(12)
    ds_read_b64_tr_b16 a[56:57], v251 offset:14336
    v_pk_mul_f32 v[132:133], v[132:133], v[140:141]
    v_mfma_f32_16x16x32_bf16 v[188:191], a[248:251], a[168:171], v[188:191]
    ds_read_b64_tr_b16 a[58:59], v251 offset:14848
    ds_read_b64_tr_b16 a[60:61], v252 offset:14336
    ds_read_b64_tr_b16 a[62:63], v252 offset:14848
    v_pk_mul_f32 v[134:135], v[134:135], v[142:143]
    v_mfma_f32_16x16x32_bf16 v[204:207], a[248:251], a[172:175], v[204:207]
    s_waitcnt lgkmcnt(8)
    s_add_u32 m0, s81, 12288
    s_add_u32 s77, s77, 14336
    v_pk_mul_f32 v[136:137], v[136:137], v[144:145]
    v_mfma_f32_16x16x32_bf16 v[208:211], a[252:255], a[172:175], v[208:211]
    ds_read_b64_tr_b16 a[240:241], v26 offset:16384
    buffer_load_dwordx4 v247, s[28:31], s77 offen offset:0 lds
    v_pk_mul_f32 v[138:139], v[138:139], v[146:147]
    v_mfma_f32_16x16x32_bf16 v[192:195], a[252:255], a[168:171], v[192:195]
    ds_read_b64_tr_b16 a[242:243], v26 offset:16896
    buffer_load_dwordx4 v248, s[28:31], s77 offen offset:1024 lds
    v_cvt_pk_bf16_f32 v132, v132, v133
    v_mfma_f32_16x16x32_bf16 v[176:179], a[252:255], a[164:167], v[176:179]
    v_cvt_pk_bf16_f32 v133, v134, v135
    v_cvt_pk_bf16_f32 v134, v136, v137
    v_cvt_pk_bf16_f32 v135, v138, v139
    v_mfma_f32_16x16x32_bf16 v[160:163], a[252:255], a[160:163], v[160:163]
    v_permlane32_swap_b32 v132, v134
    v_permlane32_swap_b32 v133, v135
    v_mfma_f32_16x16x32_bf16 v[148:151], a[224:227], a[176:179], v[148:151]
    ds_read_b64_tr_b16 a[244:245], v27 offset:16384
    s_or_b64 s[64:65], s[64:65], s[66:67]
    s_mov_b64 exec, s[64:65]
    buffer_load_dword v48, v51, s[24:27], 0 offen sc1
    s_mov_b64 exec, -1
    v_mfma_f32_16x16x32_bf16 v[164:167], a[224:227], a[180:183], v[164:167]
    ds_read_b64_tr_b16 a[246:247], v27 offset:16896
    v_permlane16_swap_b32 v132, v134
    v_permlane16_swap_b32 v133, v135
    v_mfma_f32_16x16x32_bf16 v[180:183], a[224:227], a[184:187], v[180:183]
    s_waitcnt lgkmcnt(4)
    s_add_u32 m0, s81, 14336
    s_add_u32 s77, s77, 14336
    v_mfma_f32_16x16x32_bf16 v[196:199], a[224:227], a[188:191], v[196:199]
    buffer_load_dwordx4 v247, s[28:31], s77 offen offset:0 lds
    v_cmp_gt_i32 s[88:89], 0, v240
    v_mfma_f32_16x16x32_bf16 v[200:203], a[228:231], a[188:191], v[200:203]
    ds_read_b64_tr_b16 a[248:249], v26 offset:18432
    buffer_load_dwordx4 v248, s[28:31], s77 offen offset:1024 lds
    v_mfma_f32_16x16x32_bf16 v[184:187], a[228:231], a[184:187], v[184:187]
    ds_read_b64_tr_b16 a[250:251], v26 offset:18944
    v_cmp_gt_i32 s[90:91], 1, v240
    v_cndmask_b32 v52, 0, v241, s[88:89]
    v_mfma_f32_16x16x32_bf16 v[168:171], a[228:231], a[180:183], v[168:171]
    v_cmp_gt_i32 s[88:89], 2, v240
    v_sub_f32_e64 v68, v241, v52
    v_cndmask_b32 v53, 0, v241, s[90:91]
    v_mfma_f32_16x16x32_bf16 v[152:155], a[228:231], a[176:179], v[152:155]
    v_cmp_gt_i32 s[90:91], 3, v240
    v_sub_f32_e64 v69, v241, v53
    v_cndmask_b32 v54, 0, v241, s[88:89]
    v_mfma_f32_16x16x32_bf16 v[156:159], a[232:235], a[176:179], v[156:159]
    ds_read_b64_tr_b16 a[252:253], v27 offset:18432
    v_cmp_gt_i32 s[88:89], 8, v240
    v_sub_f32_e64 v70, v241, v54
    v_mfma_f32_16x16x32_bf16 v[172:175], a[232:235], a[180:183], v[172:175]
    ds_read_b64_tr_b16 a[254:255], v27 offset:18944
    v_cndmask_b32 v55, 0, v241, s[90:91]
    v_cmp_gt_i32 s[90:91], 9, v240
    v_mfma_f32_16x16x32_bf16 v[188:191], a[232:235], a[184:187], v[188:191]
    v_sub_f32_e64 v71, v241, v55
    v_mfma_f32_16x16x32_bf16 v[204:207], a[232:235], a[188:191], v[204:207]
    v_cndmask_b32 v56, 0, v241, s[88:89]
    v_mfma_f32_16x16x32_bf16 v[208:211], a[236:239], a[188:191], v[208:211]
    ds_read_b64_tr_b16 a[224:225], v26 offset:24576
    v_cmp_gt_i32 s[88:89], 10, v240
    v_mfma_f32_16x16x32_bf16 v[192:195], a[236:239], a[184:187], v[192:195]
    ds_read_b64_tr_b16 a[226:227], v26 offset:25088
    v_sub_f32_e64 v72, v241, v56
    v_mfma_f32_16x16x32_bf16 v[176:179], a[236:239], a[180:183], v[176:179]
    v_cndmask_b32 v57, 0, v241, s[90:91]
    v_mfma_f32_16x16x32_bf16 v[160:163], a[236:239], a[176:179], v[160:163]
    v_cmp_gt_i32 s[90:91], 11, v240
    s_waitcnt lgkmcnt(8)
    v_mfma_f32_16x16x32_bf16 v[148:151], a[240:243], a[192:195], v[148:151]
    ds_read_b64_tr_b16 a[228:229], v27 offset:24576
    v_sub_f32_e32 v73, v241, v57
    v_cndmask_b32 v58, 0, v241, s[88:89]
    v_mfma_f32_16x16x32_bf16 v[164:167], a[240:243], a[196:199], v[164:167]
    ds_read_b64_tr_b16 a[230:231], v27 offset:25088
    v_cmp_gt_i32 s[88:89], 16, v240
    v_mfma_f32_16x16x32_bf16 v[180:183], a[240:243], a[200:203], v[180:183]
    v_sub_f32_e64 v74, v241, v58
    v_mfma_f32_16x16x32_bf16 v[196:199], a[240:243], a[204:207], v[196:199]
    v_cndmask_b32 v59, 0, v241, s[90:91]
    s_waitcnt lgkmcnt(8)
    v_mfma_f32_16x16x32_bf16 v[200:203], a[244:247], a[204:207], v[200:203]
    ds_read_b64_tr_b16 a[232:233], v26 offset:26624
    v_cmp_gt_i32 s[90:91], 17, v240
    v_mfma_f32_16x16x32_bf16 v[184:187], a[244:247], a[200:203], v[184:187]
    ds_read_b64_tr_b16 a[234:235], v26 offset:27136
    v_sub_f32_e32 v75, v241, v59
    v_mfma_f32_16x16x32_bf16 v[168:171], a[244:247], a[196:199], v[168:171]
    v_cndmask_b32 v60, 0, v241, s[88:89]
    v_mfma_f32_16x16x32_bf16 v[152:155], a[244:247], a[192:195], v[152:155]
    v_cmp_gt_i32 s[88:89], 18, v240
    s_waitcnt lgkmcnt(8)
    v_mfma_f32_16x16x32_bf16 v[156:159], a[248:251], a[192:195], v[156:159]
    ds_read_b64_tr_b16 a[236:237], v27 offset:26624
    v_sub_f32_e32 v76, v241, v60
    v_mfma_f32_16x16x32_bf16 v[172:175], a[248:251], a[196:199], v[172:175]
    ds_read_b64_tr_b16 a[238:239], v27 offset:27136
    v_cndmask_b32 v61, 0, v241, s[90:91]
    v_mfma_f32_16x16x32_bf16 v[188:191], a[248:251], a[200:203], v[188:191]
    v_cmp_gt_i32 s[90:91], 19, v240
    v_mfma_f32_16x16x32_bf16 v[204:207], a[248:251], a[204:207], v[204:207]
    v_sub_f32_e64 v77, v241, v61
    s_waitcnt lgkmcnt(8)
    v_mfma_f32_16x16x32_bf16 v[208:211], a[252:255], a[204:207], v[208:211]
    s_waitcnt vmcnt(2)
    v_cmp_ne_u32 vcc, s57, v48
    s_nop 1
    s_and_b64 vcc, vcc, s[64:65]
    s_cbranch_scc0 L_pok12
    s_mov_b32 s84, 0
L_psp12:
    s_sleep 2
    s_mov_b64 exec, s[64:65]
    buffer_load_dword v48, v51, s[24:27], 0 offen sc1
    s_mov_b64 exec, -1
    s_add_u32 s84, s84, 1
    s_cmp_gt_u32 s84, 1048576
    s_cbranch_scc1 L_exit
    s_waitcnt vmcnt(0)
    v_cmp_ne_u32 vcc, s57, v48
    s_nop 1
    s_and_b64 vcc, vcc, s[64:65]
    s_cbranch_scc1 L_psp12
L_pok12:
    v_mfma_f32_16x16x32_bf16 v[192:195], a[252:255], a[200:203], v[192:195]
    s_mul_i32 s86, s44, 6144
    s_add_u32 m0, s86, 0
    v_cndmask_b32 v62, 0, v241, s[88:89]
    v_mfma_f32_16x16x32_bf16 v[176:179], a[252:255], a[196:199], v[176:179]
    buffer_load_dwordx4 v[212:215], v1, s[24:27], s73 offen offset:0 sc1
    v_cmp_gt_i32 s[88:89], 24, v240
    v_mfma_f32_16x16x32_bf16 v[160:163], a[252:255], a[192:195], v[160:163]
    buffer_load_dwordx4 v1, s[24:27], s70 offen offset:0 sc1 lds
    s_waitcnt lgkmcnt(6)
    v_mfma_f32_16x16x32_bf16 v[148:151], a[224:227], a[208:211], v[148:151]
    buffer_load_dwordx4 v1, s[24:27], s70 offen offset:1024 sc1 lds
    s_add_u32 m0, s86, 2048
    v_mfma_f32_16x16x32_bf16 v[164:167], a[224:227], a[212:215], v[164:167]
    buffer_load_dwordx4 v[216:219], v1, s[24:27], s73 offen offset:1024 sc1
    v_sub_f32_e32 v78, v241, v62
    v_mfma_f32_16x16x32_bf16 v[180:183], a[224:227], a[216:219], v[180:183]
    buffer_load_dwordx4 v1, s[24:27], s71 offen offset:0 sc1 lds
    v_cndmask_b32 v63, 0, v241, s[90:91]
    v_mfma_f32_16x16x32_bf16 v[196:199], a[224:227], a[220:223], v[196:199]
    buffer_load_dwordx4 v1, s[24:27], s71 offen offset:1024 sc1 lds
    s_waitcnt lgkmcnt(4)
    v_mfma_f32_16x16x32_bf16 v[200:203], a[228:231], a[220:223], v[200:203]
    s_add_u32 m0, s86, 4096
    v_cmp_gt_i32 s[90:91], 25, v240
    v_sub_f32_e32 v79, v241, v63
    v_mfma_f32_16x16x32_bf16 v[184:187], a[228:231], a[216:219], v[184:187]
    buffer_load_dwordx4 v1, s[24:27], s72 offen offset:0 sc1 lds
    v_cndmask_b32 v64, 0, v241, s[88:89]
    v_mfma_f32_16x16x32_bf16 v[168:171], a[228:231], a[212:215], v[168:171]
    buffer_load_dwordx4 v1, s[24:27], s72 offen offset:1024 sc1 lds
    s_mul_i32 s86, s44, 6144
    v_mfma_f32_16x16x32_bf16 v[152:155], a[228:231], a[208:211], v[152:155]
    s_add_u32 m0, s86, 24576
    s_add_u32 s87, s70, 28672
    s_waitcnt lgkmcnt(2)
    v_mfma_f32_16x16x32_bf16 v[156:159], a[232:235], a[208:211], v[156:159]
    buffer_load_dwordx4 v228, s[24:27], s87 offen offset:0 sc1 lds
    v_cmp_gt_i32 s[88:89], 26, v240
    v_mfma_f32_16x16x32_bf16 v[172:175], a[232:235], a[212:215], v[172:175]
    buffer_load_dwordx4 v229, s[24:27], s87 offen offset:1024 sc1 lds
    v_sub_f32_e32 v80, v241, v64
    v_mfma_f32_16x16x32_bf16 v[188:191], a[232:235], a[216:219], v[188:191]
    s_add_u32 m0, s86, 26624
    s_add_u32 s87, s71, 28672
    v_cndmask_b32 v65, 0, v241, s[90:91]
    v_mfma_f32_16x16x32_bf16 v[204:207], a[232:235], a[220:223], v[204:207]
    buffer_load_dwordx4 v228, s[24:27], s87 offen offset:0 sc1 lds
    s_waitcnt lgkmcnt(0)
    v_mfma_f32_16x16x32_bf16 v[208:211], a[236:239], a[220:223], v[208:211]
    buffer_load_dwordx4 v229, s[24:27], s87 offen offset:1024 sc1 lds
    s_add_u32 m0, s86, 28672
    s_add_u32 s87, s72, 28672
    buffer_load_dwordx4 v228, s[24:27], s87 offen offset:0 sc1 lds
    buffer_load_dwordx4 v229, s[24:27], s87 offen offset:1024 sc1 lds
    v_mfma_f32_16x16x32_bf16 v[192:195], a[236:239], a[216:219], v[192:195]
    v_cmp_gt_i32 s[90:91], 27, v240
    v_sub_f32_e32 v81, v241, v65
    v_cndmask_b32 v66, 0, v241, s[88:89]
    v_mfma_f32_16x16x32_bf16 v[176:179], a[236:239], a[212:215], v[176:179]
    v_sub_f32_e64 v82, v241, v66
    v_cndmask_b32 v67, 0, v241, s[90:91]
    v_sub_f32_e64 v83, v241, v67
    v_mfma_f32_16x16x32_bf16 v[160:163], a[236:239], a[208:211], v[160:163]
    v_pk_mul_f32 v[148:149], v[148:149], s[62:63] op_sel_hi:[1,0]
    buffer_store_dwordx4 v[84:87], v10, s[24:27], s60 offen offset:0 sc1
    v_pk_mul_f32 v[150:151], v[150:151], s[62:63] op_sel_hi:[1,0]
    v_pk_mul_f32 v[152:153], v[152:153], s[62:63] op_sel_hi:[1,0]
    v_pk_mul_f32 v[154:155], v[154:155], s[62:63] op_sel_hi:[1,0]
    v_exp_f32_e64 v148, v148
    v_exp_f32_e64 v149, v149
    v_exp_f32_e64 v150, v150
    v_exp_f32_e64 v151, v151
    v_exp_f32_e64 v152, v152
    v_exp_f32_e64 v153, v153
    v_exp_f32_e64 v154, v154
    v_exp_f32_e64 v155, v155
    v_pk_add_f32 v[148:149], v[148:149], 1.0 op_sel_hi:[1,0]
    v_pk_add_f32 v[150:151], v[150:151], 1.0 op_sel_hi:[1,0]
    v_pk_add_f32 v[152:153], v[152:153], 1.0 op_sel_hi:[1,0]
    v_pk_add_f32 v[154:155], v[154:155], 1.0 op_sel_hi:[1,0]
    buffer_store_dwordx4 v[100:103], v10, s[24:27], s60 offen offset:256 sc1
    v_rcp_f32_e64 v148, v148
    v_rcp_f32_e64 v149, v149
    v_rcp_f32_e64 v150, v150
    v_rcp_f32_e64 v151, v151
    v_rcp_f32_e64 v152, v152
    v_rcp_f32_e64 v153, v153
    v_rcp_f32_e64 v154, v154
    v_rcp_f32_e64 v155, v155
    v_pk_mul_f32 v[148:149], v[148:149], v[156:157]
    v_pk_mul_f32 v[150:151], v[150:151], v[158:159]
    v_pk_mul_f32 v[152:153], v[152:153], v[160:161]
    v_pk_mul_f32 v[154:155], v[154:155], v[162:163]
    v_cvt_pk_bf16_f32 v148, v148, v149
    v_cvt_pk_bf16_f32 v149, v150, v151
    v_cvt_pk_bf16_f32 v150, v152, v153
    buffer_store_dwordx4 v[116:119], v10, s[24:27], s61 offen offset:0 sc1
    v_cvt_pk_bf16_f32 v151, v154, v155
    v_permlane32_swap_b32 v148, v150
    s_nop 0
    v_permlane32_swap_b32 v149, v151
    v_permlane16_swap_b32 v148, v150
    s_nop 0
    v_permlane16_swap_b32 v149, v151
    v_pk_mul_f32 v[164:165], v[164:165], s[62:63] op_sel_hi:[1,0]
    v_pk_mul_f32 v[166:167], v[166:167], s[62:63] op_sel_hi:[1,0]
    v_pk_mul_f32 v[168:169], v[168:169], s[62:63] op_sel_hi:[1,0]
    v_pk_mul_f32 v[170:171], v[170:171], s[62:63] op_sel_hi:[1,0]
    v_exp_f32_e64 v164, v164
    v_exp_f32_e64 v165, v165
    v_exp_f32_e64 v166, v166
    v_exp_f32_e64 v167, v167
    v_exp_f32_e64 v168, v168
    v_exp_f32_e64 v169, v169
    buffer_store_dwordx4 v[132:135], v10, s[24:27], s61 offen offset:256 sc1
    s_add_u32 s60, s60, 0x1000
    s_add_u32 s61, s61, 0x1000
    v_exp_f32_e64 v170, v170
    v_exp_f32_e64 v171, v171
    v_pk_add_f32 v[164:165], v[164:165], 1.0 op_sel_hi:[1,0]
    v_pk_add_f32 v[166:167], v[166:167], 1.0 op_sel_hi:[1,0]
    v_pk_add_f32 v[168:169], v[168:169], 1.0 op_sel_hi:[1,0]
    v_pk_add_f32 v[170:171], v[170:171], 1.0 op_sel_hi:[1,0]
    v_rcp_f32_e64 v164, v164
    v_rcp_f32_e64 v165, v165
    v_rcp_f32_e64 v166, v166
    v_rcp_f32_e64 v167, v167
    v_rcp_f32_e64 v168, v168
    v_rcp_f32_e64 v169, v169
    v_rcp_f32_e64 v170, v170
    v_rcp_f32_e64 v171, v171
    v_pk_mul_f32 v[164:165], v[164:165], v[172:173]
    v_pk_mul_f32 v[166:167], v[166:167], v[174:175]
    v_pk_mul_f32 v[168:169], v[168:169], v[176:177]
    v_pk_mul_f32 v[170:171], v[170:171], v[178:179]
    v_cvt_pk_bf16_f32 v164, v164, v165
    v_cvt_pk_bf16_f32 v165, v166, v167
    v_cvt_pk_bf16_f32 v166, v168, v169
    v_cvt_pk_bf16_f32 v167, v170, v171
    s_nop 0
    v_permlane32_swap_b32 v164, v166
    v_permlane32_swap_b32 v165, v167
    s_nop 0
    v_permlane16_swap_b32 v164, v166
    v_permlane16_swap_b32 v165, v167
    s_waitcnt vmcnt(10)
    ds_write_b64 v226, v[220:221]
    ds_write_b64 v227, v[222:223] offset:4096
    v_bfi_b32 v212, v30, v212, v224
    v_and_b32_e32 v213, v30, v213
    v_bfi_b32 v218, v32, v218, v224
    v_and_b32_e64 v219, v32, v219
    s_waitcnt lgkmcnt(0)
    s_barrier
    ds_read_b128 v[12:15], v236 offset:16384
    ds_read_b128 v[16:19], v236 offset:17408
    ds_read_b128 v[20:23], v236 offset:0
    ds_read_b128 v[24:27], v236 offset:1024
    v_mul_f32_e64 v180, s62, v180
    v_mul_f32_e64 v181, s62, v181
    v_mul_f32_e64 v182, s62, v182
    v_mul_f32_e64 v183, s62, v183
    v_mul_f32_e64 v184, s62, v184
    v_mul_f32_e64 v185, s62, v185
    v_mul_f32_e64 v186, s62, v186
    v_mul_f32_e64 v187, s62, v187
    v_exp_f32_e64 v180, v180
    v_exp_f32_e64 v181, v181
    v_exp_f32_e64 v182, v182
    v_exp_f32_e64 v183, v183
    v_exp_f32_e64 v184, v184
    v_exp_f32_e64 v185, v185
    v_exp_f32_e64 v186, v186
    v_exp_f32_e64 v187, v187
    s_waitcnt lgkmcnt(3)
    v_mfma_f32_32x32x16_bf16 v[52:67], v[12:15], v[212:215], v[52:67]
    ds_read_b128 v[2:5], v236 offset:14336
    ds_read_b128 v[6:9], v236 offset:15360
    v_add_f32_e32 v180, 1.0, v180
    v_add_f32_e64 v181, 1.0, v181
    v_add_f32_e64 v182, 1.0, v182
    v_add_f32_e64 v183, 1.0, v183
    v_add_f32_e64 v184, 1.0, v184
    v_add_f32_e64 v185, 1.0, v185
    v_add_f32_e64 v186, 1.0, v186
    s_waitcnt lgkmcnt(4)
    v_mfma_f32_32x32x16_bf16 v[52:67], v[16:19], v[216:219], v[52:67]
    v_add_f32_e32 v187, 1.0, v187
    v_rcp_f32_e64 v180, v180
    v_rcp_f32_e64 v181, v181
    v_rcp_f32_e64 v182, v182
    v_rcp_f32_e64 v183, v183
    v_rcp_f32_e64 v184, v184
    v_rcp_f32_e64 v185, v185
    buffer_store_dwordx4 v[148:151], v10, s[24:27], s60 offen offset:0 sc1
    s_waitcnt lgkmcnt(3)
    v_mfma_f32_32x32x16_bf16 v[68:83], v[20:23], v[212:215], v[68:83]
    ds_read_b128 v[12:15], v236 offset:12288
    ds_read_b128 v[16:19], v236 offset:13312
    v_rcp_f32_e32 v186, v186
    v_rcp_f32_e64 v187, v187
    v_mul_f32_e64 v180, v180, v188
    v_mul_f32_e64 v181, v181, v189
    v_mul_f32_e64 v182, v182, v190
    v_mul_f32_e64 v183, v183, v191
    v_mul_f32_e64 v184, v184, v192
    s_waitcnt lgkmcnt(4)
    v_mfma_f32_32x32x16_bf16 v[68:83], v[24:27], v[216:219], v[68:83]
    v_mul_f32_e32 v185, v185, v193
    v_mul_f32_e64 v186, v186, v194
    v_mul_f32_e64 v187, v187, v195
    v_cvt_pk_bf16_f32 v180, v180, v181
    v_cvt_pk_bf16_f32 v181, v182, v183
    v_cvt_pk_bf16_f32 v182, v184, v185
    v_cvt_pk_bf16_f32 v183, v186, v187
    s_waitcnt lgkmcnt(3)
    v_mfma_f32_32x32x16_bf16 v[84:99], v[2:5], v[212:215], 0
    ds_read_b128 v[20:23], v236 offset:10240
    ds_read_b128 v[24:27], v236 offset:11264
    v_permlane32_swap_b32 v180, v182
    v_permlane32_swap_b32 v181, v183
    s_nop 0
    v_permlane16_swap_b32 v180, v182
    v_permlane16_swap_b32 v181, v183
    v_mul_f32_e64 v196, s62, v196
    v_mul_f32_e64 v197, s62, v197
    v_mul_f32_e64 v198, s62, v198
    s_waitcnt lgkmcnt(4)
    v_mfma_f32_32x32x16_bf16 v[84:99], v[6:9], v[216:219], v[84:99]
    v_mul_f32_e32 v199, s62, v199
    v_mul_f32_e64 v200, s62, v200
    v_mul_f32_e64 v201, s62, v201
    v_mul_f32_e64 v202, s62, v202
    v_mul_f32_e64 v203, s62, v203
    v_exp_f32_e64 v196, v196
    v_exp_f32_e64 v197, v197
    buffer_store_dwordx4 v[164:167], v10, s[24:27], s60 offen offset:256 sc1
    s_waitcnt lgkmcnt(3)
    v_mfma_f32_32x32x16_bf16 v[100:115], v[12:15], v[212:215], 0
    ds_read_b128 v[2:5], v236 offset:8192
    ds_read_b128 v[6:9], v236 offset:9216
    v_exp_f32_e32 v198, v198
    v_exp_f32_e64 v199, v199
    v_exp_f32_e64 v200, v200
    v_exp_f32_e64 v201, v201
    v_exp_f32_e64 v202, v202
    v_exp_f32_e64 v203, v203
    v_add_f32_e64 v196, 1.0, v196
    s_waitcnt lgkmcnt(4)
    v_mfma_f32_32x32x16_bf16 v[100:115], v[16:19], v[216:219], v[100:115]
    v_add_f32_e32 v197, 1.0, v197
    v_add_f32_e64 v198, 1.0, v198
    v_add_f32_e64 v199, 1.0, v199
    v_add_f32_e64 v200, 1.0, v200
    v_add_f32_e64 v201, 1.0, v201
    v_add_f32_e64 v202, 1.0, v202
    v_add_f32_e64 v203, 1.0, v203
    s_waitcnt lgkmcnt(3)
    v_mfma_f32_32x32x16_bf16 v[116:131], v[20:23], v[212:215], 0
    ds_read_b128 v[12:15], v236 offset:6144
    ds_read_b128 v[16:19], v236 offset:7168
    v_rcp_f32_e32 v196, v196
    v_rcp_f32_e64 v197, v197
    v_rcp_f32_e64 v198, v198
    v_rcp_f32_e64 v199, v199
    v_rcp_f32_e64 v200, v200
    v_rcp_f32_e64 v201, v201
    s_waitcnt lgkmcnt(4)
    v_mfma_f32_32x32x16_bf16 v[116:131], v[24:27], v[216:219], v[116:131]
    v_rcp_f32_e32 v202, v202
    v_rcp_f32_e64 v203, v203
    v_mul_f32_e64 v196, v196, v204
    v_mul_f32_e64 v197, v197, v205
    v_mul_f32_e64 v198, v198, v206
    v_mul_f32_e64 v199, v199, v207
    s_waitcnt lgkmcnt(3)
    v_mfma_f32_32x32x16_bf16 v[132:147], v[2:5], v[212:215], 0
    ds_read_b128 v[20:23], v236 offset:4096
    ds_read_b128 v[24:27], v236 offset:5120
    v_mul_f32_e32 v200, v200, v208
    v_mul_f32_e64 v201, v201, v209
    v_mul_f32_e64 v202, v202, v210
    v_mul_f32_e64 v203, v203, v211
    v_cvt_pk_bf16_f32 v196, v196, v197
    v_cvt_pk_bf16_f32 v197, v198, v199
    s_waitcnt lgkmcnt(4)
    v_mfma_f32_32x32x16_bf16 v[132:147], v[6:9], v[216:219], v[132:147]
    v_cvt_pk_bf16_f32 v198, v200, v201
    v_cvt_pk_bf16_f32 v199, v202, v203
    s_nop 0
    v_permlane32_swap_b32 v196, v198
    v_permlane32_swap_b32 v197, v199
    s_nop 0
    v_permlane16_swap_b32 v196, v198
    s_add_u32 m0, s80, 0
    s_add_u32 s77, s77, 14336
    v_permlane16_swap_b32 v197, v199
    buffer_load_dwordx4 v247, s[28:31], s77 offen offset:0 lds
    buffer_store_dwordx4 v[180:183], v10, s[24:27], s61 offen offset:0 sc1
    s_waitcnt lgkmcnt(3)
    v_mfma_f32_32x32x16_bf16 v[148:163], v[12:15], v[212:215], 0
    ds_read_b128 v[2:5], v236 offset:2048
    ds_read_b128 v[6:9], v236 offset:3072
    v_max_f32_e32 v240, v52, v53
    v_max_f32_e64 v241, v54, v55
    v_max3_f32 v240, v240, v56, v57
    v_max3_f32 v241, v241, v58, v59
    v_max3_f32 v240, v240, v60, v61
    s_waitcnt lgkmcnt(4)
    v_mfma_f32_32x32x16_bf16 v[148:163], v[16:19], v[216:219], v[148:163]
    buffer_store_dwordx4 v[196:199], v10, s[24:27], s61 offen offset:256 sc1
    v_max3_f32 v241, v241, v62, v63
    v_max3_f32 v240, v240, v64, v65
    v_max3_f32 v241, v241, v66, v67
    v_max3_f32 v240, v240, v68, v69
    v_max3_f32 v241, v241, v70, v71
    s_waitcnt lgkmcnt(3)
    v_mfma_f32_32x32x16_bf16 v[164:179], v[20:23], v[212:215], 0
    v_max3_f32 v240, v240, v72, v73
    v_max3_f32 v241, v241, v74, v75
    v_max3_f32 v240, v240, v76, v77
    v_max3_f32 v241, v241, v78, v79
    v_max3_f32 v240, v240, v80, v81
    s_waitcnt lgkmcnt(2)
    v_mfma_f32_32x32x16_bf16 v[164:179], v[24:27], v[216:219], v[164:179]
    v_max3_f32 v241, v241, v82, v83
    v_max3_f32 v240, v240, v84, v85
    v_max3_f32 v241, v241, v86, v87
    v_max3_f32 v240, v240, v88, v89
    v_max3_f32 v241, v241, v90, v91
    s_waitcnt lgkmcnt(1)
    v_mfma_f32_32x32x16_bf16 v[180:195], v[2:5], v[212:215], 0
    v_max3_f32 v240, v240, v92, v93
    v_max3_f32 v241, v241, v94, v95
    v_max3_f32 v240, v240, v96, v97
    v_max3_f32 v241, v241, v98, v99
    v_max3_f32 v240, v240, v100, v101
    s_waitcnt lgkmcnt(0)
    v_mfma_f32_32x32x16_bf16 v[180:195], v[6:9], v[216:219], v[180:195]
    v_max3_f32 v241, v241, v102, v103
    v_max3_f32 v240, v240, v104, v105
    v_max3_f32 v241, v241, v106, v107
    v_max3_f32 v240, v240, v108, v109
    v_max3_f32 v241, v241, v110, v111
    v_max3_f32 v240, v240, v112, v113
    v_max3_f32 v241, v241, v114, v115
    v_max3_f32 v240, v240, v116, v117
    v_max3_f32 v241, v241, v118, v119
    v_max3_f32 v240, v240, v120, v121
    v_max3_f32 v241, v241, v122, v123
    v_max3_f32 v240, v240, v124, v125
    v_max3_f32 v241, v241, v126, v127
    v_max3_f32 v240, v240, v128, v129
    v_max3_f32 v241, v241, v130, v131
    v_max3_f32 v240, v240, v132, v133
    v_max3_f32 v241, v241, v134, v135
    v_max3_f32 v240, v240, v136, v137
    v_max3_f32 v241, v241, v138, v139
    v_max3_f32 v240, v240, v140, v141
    v_max3_f32 v241, v241, v142, v143
    v_max3_f32 v240, v240, v144, v145
    v_max3_f32 v241, v241, v146, v147
    v_max3_f32 v240, v240, v148, v149
    v_max3_f32 v241, v241, v150, v151
    v_max3_f32 v240, v240, v152, v153
    v_max3_f32 v241, v241, v154, v155
    v_max3_f32 v240, v240, v156, v157
    v_max3_f32 v241, v241, v158, v159
    buffer_load_dwordx4 v248, s[28:31], s77 offen offset:1024 lds
    v_max3_f32 v240, v240, v160, v161
    v_max3_f32 v241, v241, v162, v163
    v_max3_f32 v240, v240, v164, v165
    v_max3_f32 v241, v241, v166, v167
    v_max3_f32 v240, v240, v168, v169
    v_max3_f32 v241, v241, v170, v171
    v_max3_f32 v240, v240, v172, v173
    v_max3_f32 v241, v241, v174, v175
    v_max3_f32 v240, v240, v176, v177
    v_max3_f32 v241, v241, v178, v179
    s_waitcnt vmcnt(10)
    ds_write_b64 v226, v[224:225] offset:24576
    ds_write_b64 v227, v[224:225] offset:28672
    v_max3_f32 v240, v240, v180, v181
    v_max3_f32 v241, v241, v182, v183
    v_max3_f32 v240, v240, v184, v185
    v_max3_f32 v241, v241, v186, v187
    v_max3_f32 v240, v240, v188, v189
    v_max3_f32 v241, v241, v190, v191
    v_max3_f32 v240, v240, v192, v193
    v_max3_f32 v241, v241, v194, v195
    s_waitcnt lgkmcnt(0)
    s_barrier
    s_branch L_join
L_vpath:
    s_add_u32 m0, s54, 49152
    s_nop 0
    buffer_load_dwordx4 v6, s[12:15], s55 offen offset:0 lds
    buffer_load_dwordx4 v7, s[12:15], s55 offen offset:1024 lds
    s_add_u32 m0, s54, 51200
    s_add_u32 s55, s55, s52
    s_add_u32 s56, s56, s52
    s_add_u32 m0, s54, 65536
    s_nop 0
    buffer_load_dwordx4 v6, s[12:15], s55 offen offset:0 lds
    buffer_load_dwordx4 v7, s[12:15], s55 offen offset:1024 lds
    s_add_u32 m0, s54, 67584
    s_add_u32 s55, s55, s52
    s_add_u32 s56, s56, s52
    s_add_u32 m0, s54, 81920
    s_nop 0
    buffer_load_dwordx4 v6, s[12:15], s55 offen offset:0 lds
    buffer_load_dwordx4 v7, s[12:15], s55 offen offset:1024 lds
    s_add_u32 m0, s54, 83968
    s_add_u32 s55, s55, s52
    s_add_u32 s56, s56, s52
    s_mov_b32 s20, s42
    s_mov_b32 s21, s43
    s_mov_b32 s22, 896
    s_mov_b32 s23, 0x20000
    s_add_u32 m0, s54, 32768
    s_nop 0
    buffer_load_dwordx4 v1, s[20:23], 0 offen lds
    s_sub_u32 s3, s58, 0x2000
    s_sub_u32 s4, s59, 0x2000
    v_readfirstlane_b32 s57, v48
    s_nop 1
    s_cmp_lg_u32 s57, 0
    s_cbranch_scc1 L_gottag13
    s_mov_b32 s84, 0
L_tagspin13:
    global_load_dword v48, v49, s[40:41] sc1
    s_add_u32 s84, s84, 1
    s_cmp_gt_u32 s84, 1048576
    s_cbranch_scc1 L_exit
    s_waitcnt vmcnt(0)
    v_readfirstlane_b32 s57, v48
    s_nop 1
    s_cmp_lg_u32 s57, 0
    s_cbranch_scc0 L_tagspin13
L_gottag13:
    s_and_b32 s88, s44, 1
    s_sub_u32 s89, s46, 14
    s_xor_b32 s88, s88, s89
    s_lshl_b32 s88, s88, 6
    v_xor_b32_e32 v24, s88, v24
    v_xor_b32_e64 v25, s88, v25
    v_xor_b32_e64 v26, s88, v26
    v_xor_b32_e64 v27, s88, v27
    v_xor_b32_e64 v28, s88, v28
    v_xor_b32_e64 v29, s88, v29
    s_lshl_b32 s88, s45, 2
    s_add_u32 s88, s88, s44
    s_mul_i32 s88, s88, 86016
    s_lshl_b32 s89, s89, 11
    s_add_u32 s88, s88, s89
    s_add_u32 s5, s88, 69632
    v_and_b32_e64 v36, 0x30, v0
    s_add_u32 s88, s54, 32768
    v_add_u32_e64 v36, s88, v36
    v_and_b32_e64 v37, 31, v0
    v_lshlrev_b32_e64 v37, 2, v37
    s_bitcmp1_b32 s44, 0
    s_cbranch_scc1 L_v_wc1
    s_waitcnt lgkmcnt(0)
    ds_read_b64_tr_b16 a[224:225], v26 offset:57344
    ds_read_b64_tr_b16 a[226:227], v26 offset:57856
    ds_read_b64_tr_b16 a[228:229], v27 offset:57344
    ds_read_b64_tr_b16 a[230:231], v27 offset:57856
    ds_read_b64_tr_b16 a[232:233], v28 offset:0
    ds_read_b64_tr_b16 a[234:235], v28 offset:512
    ds_read_b64_tr_b16 a[236:237], v29 offset:0
    ds_read_b64_tr_b16 a[238:239], v29 offset:512
    ds_read_b64_tr_b16 a[240:241], v28 offset:8192
    ds_read_b64_tr_b16 a[242:243], v28 offset:8704
    ds_read_b64_tr_b16 a[244:245], v29 offset:8192
    ds_read_b64_tr_b16 a[246:247], v29 offset:8704
    s_waitcnt lgkmcnt(10)
    v_mfma_f32_16x16x32_bf16 v[148:151], a[224:227], a[0:3], 0
    v_cvt_pk_bf16_f32 v52, v52, v53
    v_cvt_pk_bf16_f32 v53, v54, v55
    v_mfma_f32_16x16x32_bf16 v[156:159], a[224:227], a[4:7], 0
    v_cvt_pk_bf16_f32 v54, v56, v57
    v_cvt_pk_bf16_f32 v55, v58, v59
    ds_read_b64_tr_b16 a[248:249], v28 offset:16384
    ds_read_b64_tr_b16 a[250:251], v28 offset:16896
    s_waitcnt lgkmcnt(10)
    v_mfma_f32_16x16x32_bf16 v[152:155], a[228:231], a[0:3], 0
    v_permlane32_swap_b32 v52, v54
    v_permlane32_swap_b32 v53, v55
    v_mfma_f32_16x16x32_bf16 v[160:163], a[228:231], a[4:7], 0
    v_permlane16_swap_b32 v52, v54
    v_permlane16_swap_b32 v53, v55
    ds_read_b64_tr_b16 a[252:253], v29 offset:16384
    ds_read_b64_tr_b16 a[254:255], v29 offset:16896
    s_waitcnt lgkmcnt(10)
    v_mfma_f32_16x16x32_bf16 v[148:151], a[232:235], a[16:19], v[148:151]
    buffer_store_dwordx4 v[52:55], v10, s[24:27], s58 offen offset:0 sc1
    v_cvt_pk_bf16_f32 v60, v60, v61
    v_mfma_f32_16x16x32_bf16 v[156:159], a[232:235], a[20:23], v[156:159]
    v_cvt_pk_bf16_f32 v61, v62, v63
    v_cvt_pk_bf16_f32 v62, v64, v65
    s_waitcnt vmcnt(8) lgkmcnt(0)
    s_barrier
    ds_read_b64_tr_b16 a[224:225], v24 offset:0
    ds_read_b64_tr_b16 a[226:227], v24 offset:512
    v_mfma_f32_16x16x32_bf16 v[152:155], a[236:239], a[16:19], v[152:155]
    v_cvt_pk_bf16_f32 v63, v66, v67
    v_permlane32_swap_b32 v60, v62
    v_mfma_f32_16x16x32_bf16 v[160:163], a[236:239], a[20:23], v[160:163]
    v_permlane32_swap_b32 v61, v63
    v_permlane16_swap_b32 v60, v62
    ds_read_b64_tr_b16 a[228:229], v25 offset:0
    ds_read_b64_tr_b16 a[230:231], v25 offset:512
    v_mfma_f32_16x16x32_bf16 v[148:151], a[240:243], a[32:35], v[148:151]
    v_permlane16_swap_b32 v61, v63
    buffer_store_dwordx4 v[60:63], v10, s[24:27], s58 offen offset:256 sc1
    v_mfma_f32_16x16x32_bf16 v[156:159], a[240:243], a[36:39], v[156:159]
    v_cvt_pk_bf16_f32 v68, v68, v69
    v_cvt_pk_bf16_f32 v69, v70, v71
    ds_read_b64_tr_b16 a[232:233], v24 offset:8192
    ds_read_b64_tr_b16 a[234:235], v24 offset:8704
    v_mfma_f32_16x16x32_bf16 v[152:155], a[244:247], a[32:35], v[152:155]
    v_cvt_pk_bf16_f32 v70, v72, v73
    v_cvt_pk_bf16_f32 v71, v74, v75
    v_mfma_f32_16x16x32_bf16 v[160:163], a[244:247], a[36:39], v[160:163]
    v_permlane32_swap_b32 v68, v70
    v_permlane32_swap_b32 v69, v71
    ds_read_b64_tr_b16 a[236:237], v25 offset:8192
    ds_read_b64_tr_b16 a[238:239], v25 offset:8704
    v_mfma_f32_16x16x32_bf16 v[148:151], a[248:251], a[48:51], v[148:151]
    v_permlane16_swap_b32 v68, v70
    v_permlane16_swap_b32 v69, v71
    v_mfma_f32_16x16x32_bf16 v[156:159], a[248:251], a[52:55], v[156:159]
    buffer_store_dwordx4 v[68:71], v10, s[24:27], s59 offen offset:0 sc1
    v_cvt_pk_bf16_f32 v76, v76, v77
    ds_read_b64_tr_b16 a[240:241], v24 offset:16384
    ds_read_b64_tr_b16 a[242:243], v24 offset:16896
    v_mfma_f32_16x16x32_bf16 v[152:155], a[252:255], a[48:51], v[152:155]
    v_cvt_pk_bf16_f32 v77, v78, v79
    v_cvt_pk_bf16_f32 v78, v80, v81
    v_mfma_f32_16x16x32_bf16 v[160:163], a[252:255], a[52:55], v[160:163]
    v_cvt_pk_bf16_f32 v79, v82, v83
    v_permlane32_swap_b32 v76, v78
    ds_read_b64_tr_b16 a[244:245], v25 offset:16384
    ds_read_b64_tr_b16 a[246:247], v25 offset:16896
    s_waitcnt lgkmcnt(10)
    v_mfma_f32_16x16x32_bf16 v[148:151], a[224:227], a[64:67], v[148:151]
    v_permlane32_swap_b32 v77, v79
    v_permlane16_swap_b32 v76, v78
    v_mfma_f32_16x16x32_bf16 v[156:159], a[224:227], a[68:71], v[156:159]
    v_permlane16_swap_b32 v77, v79
    buffer_store_dwordx4 v[76:79], v10, s[24:27], s59 offen offset:256 sc1
    ds_read_b64_tr_b16 a[248:249], v24 offset:24576
    ds_read_b64_tr_b16 a[250:251], v24 offset:25088
    s_waitcnt lgkmcnt(10)
    v_mfma_f32_16x16x32_bf16 v[152:155], a[228:231], a[64:67], v[152:155]
    v_cvt_pk_bf16_f32 v84, v84, v85
    v_cvt_pk_bf16_f32 v85, v86, v87
    v_mfma_f32_16x16x32_bf16 v[160:163], a[228:231], a[68:71], v[160:163]
    v_cvt_pk_bf16_f32 v86, v88, v89
    v_cvt_pk_bf16_f32 v87, v90, v91
    ds_read_b64_tr_b16 a[252:253], v25 offset:24576
    ds_read_b64_tr_b16 a[254:255], v25 offset:25088
    s_waitcnt lgkmcnt(10)
    v_mfma_f32_16x16x32_bf16 v[148:151], a[232:235], a[80:83], v[148:151]
    v_permlane32_swap_b32 v84, v86
    v_permlane32_swap_b32 v85, v87
    v_mfma_f32_16x16x32_bf16 v[156:159], a[232:235], a[84:87], v[156:159]
    v_permlane16_swap_b32 v84, v86
    v_permlane16_swap_b32 v85, v87
    s_waitcnt vmcnt(5)
    s_barrier
    ds_read_b64_tr_b16 a[224:225], v24 offset:49152
    ds_read_b64_tr_b16 a[226:227], v24 offset:49664
    s_waitcnt lgkmcnt(10)
    v_mfma_f32_16x16x32_bf16 v[152:155], a[236:239], a[80:83], v[152:155]
    buffer_store_dwordx4 v[84:87], v10, s[24:27], s3 offen offset:0 sc1
    v_cvt_pk_bf16_f32 v92, v92, v93
    v_mfma_f32_16x16x32_bf16 v[160:163], a[236:239], a[84:87], v[160:163]
    v_cvt_pk_bf16_f32 v93, v94, v95
    v_cvt_pk_bf16_f32 v94, v96, v97
    ds_read_b64_tr_b16 a[228:229], v25 offset:49152
    ds_read_b64_tr_b16 a[230:231], v25 offset:49664
    s_waitcnt lgkmcnt(10)
    v_mfma_f32_16x16x32_bf16 v[148:151], a[240:243], a[96:99], v[148:151]
    v_cvt_pk_bf16_f32 v95, v98, v99
    v_permlane32_swap_b32 v92, v94
    v_mfma_f32_16x16x32_bf16 v[156:159], a[240:243], a[100:103], v[156:159]
    v_permlane32_swap_b32 v93, v95
    v_permlane16_swap_b32 v92, v94
    ds_read_b64_tr_b16 a[232:233], v24 offset:57344
    ds_read_b64_tr_b16 a[234:235], v24 offset:57856
    s_waitcnt lgkmcnt(10)
    v_mfma_f32_16x16x32_bf16 v[152:155], a[244:247], a[96:99], v[152:155]
    v_permlane16_swap_b32 v93, v95
    buffer_store_dwordx4 v[92:95], v11, s[24:27], s3 offen offset:0 sc1
    v_mfma_f32_16x16x32_bf16 v[160:163], a[244:247], a[100:103], v[160:163]
    v_cvt_pk_bf16_f32 v100, v100, v101
    v_cvt_pk_bf16_f32 v101, v102, v103
    ds_read_b64_tr_b16 a[236:237], v25 offset:57344
    ds_read_b64_tr_b16 a[238:239], v25 offset:57856
    s_waitcnt lgkmcnt(10)
    v_mfma_f32_16x16x32_bf16 v[148:151], a[248:251], a[112:115], v[148:151]
    v_cvt_pk_bf16_f32 v102, v104, v105
    v_cvt_pk_bf16_f32 v103, v106, v107
    v_mfma_f32_16x16x32_bf16 v[156:159], a[248:251], a[116:119], v[156:159]
    v_permlane32_swap_b32 v100, v102
    v_permlane32_swap_b32 v101, v103
    ds_read_b64_tr_b16 a[240:241], v26 offset:0
    ds_read_b64_tr_b16 a[242:243], v26 offset:512
    s_waitcnt lgkmcnt(10)
    v_mfma_f32_16x16x32_bf16 v[152:155], a[252:255], a[112:115], v[152:155]
    v_permlane16_swap_b32 v100, v102
    v_permlane16_swap_b32 v101, v103
    v_mfma_f32_16x16x32_bf16 v[160:163], a[252:255], a[116:119], v[160:163]
    buffer_store_dwordx4 v[100:103], v10, s[24:27], s3 offen offset:256 sc1
    v_cvt_pk_bf16_f32 v108, v108, v109
    ds_read_b64_tr_b16 a[244:245], v27 offset:0
    ds_read_b64_tr_b16 a[246:247], v27 offset:512
    s_waitcnt lgkmcnt(10)
    v_mfma_f32_16x16x32_bf16 v[148:151], a[224:227], a[128:131], v[148:151]
    v_cvt_pk_bf16_f32 v109, v110, v111
    v_cvt_pk_bf16_f32 v110, v112, v113
    v_mfma_f32_16x16x32_bf16 v[156:159], a[224:227], a[132:135], v[156:159]
    v_cvt_pk_bf16_f32 v111, v114, v115
    v_permlane32_swap_b32 v108, v110
    ds_read_b64_tr_b16 a[248:249], v26 offset:8192
    ds_read_b64_tr_b16 a[250:251], v26 offset:8704
    s_waitcnt lgkmcnt(10)
    v_mfma_f32_16x16x32_bf16 v[152:155], a[228:231], a[128:131], v[152:155]
    v_permlane32_swap_b32 v109, v111
    v_permlane16_swap_b32 v108, v110
    v_mfma_f32_16x16x32_bf16 v[160:163], a[228:231], a[132:135], v[160:163]
    v_permlane16_swap_b32 v109, v111
    buffer_store_dwordx4 v[108:111], v11, s[24:27], s3 offen offset:256 sc1
    ds_read_b64_tr_b16 a[252:253], v27 offset:8192
    ds_read_b64_tr_b16 a[254:255], v27 offset:8704
    s_waitcnt lgkmcnt(10)
    v_mfma_f32_16x16x32_bf16 v[148:151], a[232:235], a[144:147], v[148:151]
    v_cvt_pk_bf16_f32 v116, v116, v117
    v_cvt_pk_bf16_f32 v117, v118, v119
    v_mfma_f32_16x16x32_bf16 v[156:159], a[232:235], a[148:151], v[156:159]
    v_cvt_pk_bf16_f32 v118, v120, v121
    v_cvt_pk_bf16_f32 v119, v122, v123
    ds_read_b64_tr_b16 a[224:225], v26 offset:16384
    ds_read_b64_tr_b16 a[226:227], v26 offset:16896
    s_waitcnt lgkmcnt(10)
    v_mfma_f32_16x16x32_bf16 v[152:155], a[236:239], a[144:147], v[152:155]
    v_permlane32_swap_b32 v116, v118
    v_permlane32_swap_b32 v117, v119
    v_mfma_f32_16x16x32_bf16 v[160:163], a[236:239], a[148:151], v[160:163]
    v_permlane16_swap_b32 v116, v118
    v_permlane16_swap_b32 v117, v119
    ds_read_b64_tr_b16 a[228:229], v27 offset:16384
    ds_read_b64_tr_b16 a[230:231], v27 offset:16896
    s_waitcnt lgkmcnt(10)
    v_mfma_f32_16x16x32_bf16 v[148:151], a[240:243], a[160:163], v[148:151]
    buffer_store_dwordx4 v[116:119], v10, s[24:27], s4 offen offset:0 sc1
    v_cvt_pk_bf16_f32 v124, v124, v125
    v_mfma_f32_16x16x32_bf16 v[156:159], a[240:243], a[164:167], v[156:159]
    v_cvt_pk_bf16_f32 v125, v126, v127
    v_cvt_pk_bf16_f32 v126, v128, v129
    ds_read_b64_tr_b16 a[232:233], v26 offset:24576
    ds_read_b64_tr_b16 a[234:235], v26 offset:25088
    s_waitcnt lgkmcnt(10)
    v_mfma_f32_16x16x32_bf16 v[152:155], a[244:247], a[160:163], v[152:155]
    v_cvt_pk_bf16_f32 v127, v130, v131
    v_permlane32_swap_b32 v124, v126
    v_mfma_f32_16x16x32_bf16 v[160:163], a[244:247], a[164:167], v[160:163]
    v_permlane32_swap_b32 v125, v127
    v_permlane16_swap_b32 v124, v126
    ds_read_b64_tr_b16 a[236:237], v27 offset:24576
    ds_read_b64_tr_b16 a[238:239], v27 offset:25088
    s_waitcnt lgkmcnt(10)
    v_mfma_f32_16x16x32_bf16 v[148:151], a[248:251], a[176:179], v[148:151]
    v_permlane16_swap_b32 v125, v127
    buffer_store_dwordx4 v[124:127], v11, s[24:27], s4 offen offset:0 sc1
    v_mfma_f32_16x16x32_bf16 v[156:159], a[248:251], a[180:183], v[156:159]
    v_cvt_pk_bf16_f32 v132, v132, v133
    v_cvt_pk_bf16_f32 v133, v134, v135
    s_waitcnt lgkmcnt(8)
    v_mfma_f32_16x16x32_bf16 v[152:155], a[252:255], a[176:179], v[152:155]
    v_cvt_pk_bf16_f32 v134, v136, v137
    v_cvt_pk_bf16_f32 v135, v138, v139
    v_mfma_f32_16x16x32_bf16 v[160:163], a[252:255], a[180:183], v[160:163]
    v_permlane32_swap_b32 v132, v134
    v_permlane32_swap_b32 v133, v135
    s_waitcnt lgkmcnt(6)
    v_mfma_f32_16x16x32_bf16 v[148:151], a[224:227], a[192:195], v[148:151]
    v_permlane16_swap_b32 v132, v134
    v_permlane16_swap_b32 v133, v135
    v_mfma_f32_16x16x32_bf16 v[156:159], a[224:227], a[196:199], v[156:159]
    buffer_store_dwordx4 v[132:135], v10, s[24:27], s4 offen offset:256 sc1
    v_cvt_pk_bf16_f32 v140, v140, v141
    s_waitcnt lgkmcnt(4)
    v_mfma_f32_16x16x32_bf16 v[152:155], a[228:231], a[192:195], v[152:155]
    v_cvt_pk_bf16_f32 v141, v142, v143
    v_cvt_pk_bf16_f32 v142, v144, v145
    v_mfma_f32_16x16x32_bf16 v[160:163], a[228:231], a[196:199], v[160:163]
    v_cvt_pk_bf16_f32 v143, v146, v147
    v_permlane32_swap_b32 v140, v142
    s_waitcnt lgkmcnt(2)
    v_mfma_f32_16x16x32_bf16 v[148:151], a[232:235], a[208:211], v[148:151]
    v_permlane32_swap_b32 v141, v143
    v_permlane16_swap_b32 v140, v142
    v_mfma_f32_16x16x32_bf16 v[156:159], a[232:235], a[212:215], v[156:159]
    v_permlane16_swap_b32 v141, v143
    buffer_store_dwordx4 v[140:143], v11, s[24:27], s4 offen offset:256 sc1
    s_waitcnt lgkmcnt(0)
    v_mfma_f32_16x16x32_bf16 v[152:155], a[236:239], a[208:211], v[152:155]
    v_mfma_f32_16x16x32_bf16 v[160:163], a[236:239], a[212:215], v[160:163]
    s_nop 3
    v_cvt_pk_bf16_f32 v148, v148, v149
    v_cvt_pk_bf16_f32 v149, v150, v151
    s_nop 4
    v_cvt_pk_bf16_f32 v150, v152, v153
    v_cvt_pk_bf16_f32 v151, v154, v155
    s_nop 0
    v_permlane32_swap_b32 v148, v150
    v_permlane32_swap_b32 v149, v151
    s_nop 0
    v_permlane16_swap_b32 v148, v150
    v_permlane16_swap_b32 v149, v151
    buffer_store_dwordx4 v[148:151], v10, s[24:27], s5 offen offset:0 sc1
    v_cvt_pk_bf16_f32 v156, v156, v157
    v_cvt_pk_bf16_f32 v157, v158, v159
    v_cvt_pk_bf16_f32 v158, v160, v161
    v_cvt_pk_bf16_f32 v159, v162, v163
    s_nop 0
    v_permlane32_swap_b32 v156, v158
    v_permlane32_swap_b32 v157, v159
    s_nop 0
    v_permlane16_swap_b32 v156, v158
    v_permlane16_swap_b32 v157, v159
    buffer_store_dwordx4 v[156:159], v10, s[24:27], s5 offen offset:256 sc1
    s_waitcnt vmcnt(14)
    ds_read_b128 a[224:227], v36 offset:0
    ds_read_b128 a[228:231], v36 offset:64
    ds_read_b128 a[232:235], v36 offset:128
    ds_read_b128 a[236:239], v36 offset:192
    ds_read_b128 a[240:243], v36 offset:256
    ds_read_b128 a[244:247], v36 offset:320
    s_waitcnt lgkmcnt(5)
    v_mfma_f32_16x16x32_bf16 v[164:167], a[224:227], a[0:3], 0
    v_cmp_gt_i32 s[88:89], 0, v240
    v_cmp_gt_i32 s[90:91], 1, v240
    v_mfma_f32_16x16x32_bf16 v[168:171], a[224:227], a[4:7], 0
    v_cndmask_b32 v52, 0, v241, s[88:89]
    v_cmp_gt_i32 s[88:89], 2, v240
    ds_read_b128 a[248:251], v36 offset:384
    s_waitcnt lgkmcnt(5)
    v_mfma_f32_16x16x32_bf16 v[164:167], a[228:231], a[16:19], v[164:167]
    v_sub_f32_e32 v68, v241, v52
    v_cndmask_b32 v53, 0, v241, s[90:91]
    v_mfma_f32_16x16x32_bf16 v[168:171], a[228:231], a[20:23], v[168:171]
    v_cmp_gt_i32 s[90:91], 3, v240
    v_sub_f32_e64 v69, v241, v53
    ds_read_b128 a[252:255], v36 offset:448
    s_waitcnt lgkmcnt(5)
    v_mfma_f32_16x16x32_bf16 v[164:167], a[232:235], a[32:35], v[164:167]
    v_cndmask_b32 v54, 0, v241, s[88:89]
    v_cmp_gt_i32 s[88:89], 8, v240
    v_mfma_f32_16x16x32_bf16 v[168:171], a[232:235], a[36:39], v[168:171]
    v_sub_f32_e32 v70, v241, v54
    v_cndmask_b32 v55, 0, v241, s[90:91]
    ds_read_b128 a[224:227], v36 offset:512
    s_waitcnt lgkmcnt(5)
    v_mfma_f32_16x16x32_bf16 v[164:167], a[236:239], a[48:51], v[164:167]
    v_cmp_gt_i32 s[90:91], 9, v240
    v_sub_f32_e32 v71, v241, v55
    v_mfma_f32_16x16x32_bf16 v[168:171], a[236:239], a[52:55], v[168:171]
    v_cndmask_b32 v56, 0, v241, s[88:89]
    v_cmp_gt_i32 s[88:89], 10, v240
    ds_read_b128 a[228:231], v36 offset:576
    s_waitcnt lgkmcnt(5)
    v_mfma_f32_16x16x32_bf16 v[164:167], a[240:243], a[64:67], v[164:167]
    v_sub_f32_e32 v72, v241, v56
    v_cndmask_b32 v57, 0, v241, s[90:91]
    v_mfma_f32_16x16x32_bf16 v[168:171], a[240:243], a[68:71], v[168:171]
    v_cmp_gt_i32 s[90:91], 11, v240
    v_sub_f32_e64 v73, v241, v57
    ds_read_b128 a[232:235], v36 offset:640
    s_waitcnt lgkmcnt(5)
    v_mfma_f32_16x16x32_bf16 v[164:167], a[244:247], a[80:83], v[164:167]
    v_cndmask_b32 v58, 0, v241, s[88:89]
    v_cmp_gt_i32 s[88:89], 16, v240
    v_mfma_f32_16x16x32_bf16 v[168:171], a[244:247], a[84:87], v[168:171]
    v_sub_f32_e32 v74, v241, v58
    v_cndmask_b32 v59, 0, v241, s[90:91]
    ds_read_b128 a[236:239], v36 offset:704
    s_waitcnt lgkmcnt(5)
    v_mfma_f32_16x16x32_bf16 v[164:167], a[248:251], a[96:99], v[164:167]
    v_cmp_gt_i32 s[90:91], 17, v240
    v_sub_f32_e32 v75, v241, v59
    v_mfma_f32_16x16x32_bf16 v[168:171], a[248:251], a[100:103], v[168:171]
    v_cndmask_b32 v60, 0, v241, s[88:89]
    v_cmp_gt_i32 s[88:89], 18, v240
    ds_read_b128 a[240:243], v36 offset:768
    s_waitcnt lgkmcnt(5)
    v_mfma_f32_16x16x32_bf16 v[164:167], a[252:255], a[112:115], v[164:167]
    v_sub_f32_e32 v76, v241, v60
    v_cndmask_b32 v61, 0, v241, s[90:91]
    v_mfma_f32_16x16x32_bf16 v[168:171], a[252:255], a[116:119], v[168:171]
    v_cmp_gt_i32 s[90:91], 19, v240
    v_sub_f32_e64 v77, v241, v61
    ds_read_b128 a[244:247], v36 offset:832
    s_waitcnt lgkmcnt(5)
    v_mfma_f32_16x16x32_bf16 v[164:167], a[224:227], a[128:131], v[164:167]
    v_cndmask_b32 v62, 0, v241, s[88:89]
    v_cmp_gt_i32 s[88:89], 24, v240
    v_mfma_f32_16x16x32_bf16 v[168:171], a[224:227], a[132:135], v[168:171]
    v_sub_f32_e32 v78, v241, v62
    v_cndmask_b32 v63, 0, v241, s[90:91]
    s_waitcnt lgkmcnt(4)
    v_mfma_f32_16x16x32_bf16 v[164:167], a[228:231], a[144:147], v[164:167]
    v_cmp_gt_i32 s[90:91], 25, v240
    v_sub_f32_e32 v79, v241, v63
    v_mfma_f32_16x16x32_bf16 v[168:171], a[228:231], a[148:151], v[168:171]
    v_cndmask_b32 v64, 0, v241, s[88:89]
    v_cmp_gt_i32 s[88:89], 26, v240
    s_waitcnt lgkmcnt(3)
    v_mfma_f32_16x16x32_bf16 v[164:167], a[232:235], a[160:163], v[164:167]
    v_sub_f32_e32 v80, v241, v64
    v_cndmask_b32 v65, 0, v241, s[90:91]
    v_mfma_f32_16x16x32_bf16 v[168:171], a[232:235], a[164:167], v[168:171]
    v_cmp_gt_i32 s[90:91], 27, v240
    v_sub_f32_e64 v81, v241, v65
    s_waitcnt lgkmcnt(2)
    v_mfma_f32_16x16x32_bf16 v[164:167], a[236:239], a[176:179], v[164:167]
    v_cndmask_b32 v66, 0, v241, s[88:89]
    v_sub_f32_e32 v82, v241, v66
    v_mfma_f32_16x16x32_bf16 v[168:171], a[236:239], a[180:183], v[168:171]
    v_cndmask_b32 v67, 0, v241, s[90:91]
    v_sub_f32_e64 v83, v241, v67
    s_waitcnt lgkmcnt(1)
    v_mfma_f32_16x16x32_bf16 v[164:167], a[240:243], a[192:195], v[164:167]
    v_mfma_f32_16x16x32_bf16 v[168:171], a[240:243], a[196:199], v[168:171]
    s_waitcnt lgkmcnt(0)
    v_mfma_f32_16x16x32_bf16 v[164:167], a[244:247], a[208:211], v[164:167]
    v_mfma_f32_16x16x32_bf16 v[168:171], a[244:247], a[212:215], v[168:171]
    v_and_b32_e64 v38, 16, v0
    v_cmp_eq_u32 vcc, 0, v38
    s_nop 9
    v_cndmask_b32 v38, v168, v164, vcc
    s_branch L_v_done
L_v_wc1:
    s_waitcnt lgkmcnt(0)
    ds_read_b64_tr_b16 a[224:225], v26 offset:57344
    ds_read_b64_tr_b16 a[226:227], v26 offset:57856
    ds_read_b64_tr_b16 a[228:229], v27 offset:57344
    ds_read_b64_tr_b16 a[230:231], v27 offset:57856
    ds_read_b64_tr_b16 a[232:233], v28 offset:0
    ds_read_b64_tr_b16 a[234:235], v28 offset:512
    ds_read_b64_tr_b16 a[236:237], v29 offset:0
    ds_read_b64_tr_b16 a[238:239], v29 offset:512
    ds_read_b64_tr_b16 a[240:241], v28 offset:8192
    ds_read_b64_tr_b16 a[242:243], v28 offset:8704
    ds_read_b64_tr_b16 a[244:245], v29 offset:8192
    ds_read_b64_tr_b16 a[246:247], v29 offset:8704
    s_waitcnt lgkmcnt(10)
    v_mfma_f32_16x16x32_bf16 v[148:151], a[224:227], a[8:11], 0
    v_cvt_pk_bf16_f32 v52, v52, v53
    v_cvt_pk_bf16_f32 v53, v54, v55
    v_mfma_f32_16x16x32_bf16 v[156:159], a[224:227], a[12:15], 0
    v_cvt_pk_bf16_f32 v54, v56, v57
    v_cvt_pk_bf16_f32 v55, v58, v59
    ds_read_b64_tr_b16 a[248:249], v28 offset:16384
    ds_read_b64_tr_b16 a[250:251], v28 offset:16896
    s_waitcnt lgkmcnt(10)
    v_mfma_f32_16x16x32_bf16 v[152:155], a[228:231], a[8:11], 0
    v_permlane32_swap_b32 v52, v54
    v_permlane32_swap_b32 v53, v55
    v_mfma_f32_16x16x32_bf16 v[160:163], a[228:231], a[12:15], 0
    v_permlane16_swap_b32 v52, v54
    v_permlane16_swap_b32 v53, v55
    ds_read_b64_tr_b16 a[252:253], v29 offset:16384
    ds_read_b64_tr_b16 a[254:255], v29 offset:16896
    s_waitcnt lgkmcnt(10)
    v_mfma_f32_16x16x32_bf16 v[148:151], a[232:235], a[24:27], v[148:151]
    buffer_store_dwordx4 v[52:55], v10, s[24:27], s58 offen offset:0 sc1
    v_cvt_pk_bf16_f32 v60, v60, v61
    v_mfma_f32_16x16x32_bf16 v[156:159], a[232:235], a[28:31], v[156:159]
    v_cvt_pk_bf16_f32 v61, v62, v63
    v_cvt_pk_bf16_f32 v62, v64, v65
    s_waitcnt vmcnt(8) lgkmcnt(0)
    s_barrier
    ds_read_b64_tr_b16 a[224:225], v24 offset:0
    ds_read_b64_tr_b16 a[226:227], v24 offset:512
    v_mfma_f32_16x16x32_bf16 v[152:155], a[236:239], a[24:27], v[152:155]
    v_cvt_pk_bf16_f32 v63, v66, v67
    v_permlane32_swap_b32 v60, v62
    v_mfma_f32_16x16x32_bf16 v[160:163], a[236:239], a[28:31], v[160:163]
    v_permlane32_swap_b32 v61, v63
    v_permlane16_swap_b32 v60, v62
    ds_read_b64_tr_b16 a[228:229], v25 offset:0
    ds_read_b64_tr_b16 a[230:231], v25 offset:512
    v_mfma_f32_16x16x32_bf16 v[148:151], a[240:243], a[40:43], v[148:151]
    v_permlane16_swap_b32 v61, v63
    buffer_store_dwordx4 v[60:63], v10, s[24:27], s58 offen offset:256 sc1
    v_mfma_f32_16x16x32_bf16 v[156:159], a[240:243], a[44:47], v[156:159]
    v_cvt_pk_bf16_f32 v68, v68, v69
    v_cvt_pk_bf16_f32 v69, v70, v71
    ds_read_b64_tr_b16 a[232:233], v24 offset:8192
    ds_read_b64_tr_b16 a[234:235], v24 offset:8704
    v_mfma_f32_16x16x32_bf16 v[152:155], a[244:247], a[40:43], v[152:155]
    v_cvt_pk_bf16_f32 v70, v72, v73
    v_cvt_pk_bf16_f32 v71, v74, v75
    v_mfma_f32_16x16x32_bf16 v[160:163], a[244:247], a[44:47], v[160:163]
    v_permlane32_swap_b32 v68, v70
    v_permlane32_swap_b32 v69, v71
    ds_read_b64_tr_b16 a[236:237], v25 offset:8192
    ds_read_b64_tr_b16 a[238:239], v25 offset:8704
    v_mfma_f32_16x16x32_bf16 v[148:151], a[248:251], a[56:59], v[148:151]
    v_permlane16_swap_b32 v68, v70
    v_permlane16_swap_b32 v69, v71
    v_mfma_f32_16x16x32_bf16 v[156:159], a[248:251], a[60:63], v[156:159]
    buffer_store_dwordx4 v[68:71], v10, s[24:27], s59 offen offset:0 sc1
    v_cvt_pk_bf16_f32 v76, v76, v77
    ds_read_b64_tr_b16 a[240:241], v24 offset:16384
    ds_read_b64_tr_b16 a[242:243], v24 offset:16896
    v_mfma_f32_16x16x32_bf16 v[152:155], a[252:255], a[56:59], v[152:155]
    v_cvt_pk_bf16_f32 v77, v78, v79
    v_cvt_pk_bf16_f32 v78, v80, v81
    v_mfma_f32_16x16x32_bf16 v[160:163], a[252:255], a[60:63], v[160:163]
    v_cvt_pk_bf16_f32 v79, v82, v83
    v_permlane32_swap_b32 v76, v78
    ds_read_b64_tr_b16 a[244:245], v25 offset:16384
    ds_read_b64_tr_b16 a[246:247], v25 offset:16896
    s_waitcnt lgkmcnt(10)
    v_mfma_f32_16x16x32_bf16 v[148:151], a[224:227], a[72:75], v[148:151]
    v_permlane32_swap_b32 v77, v79
    v_permlane16_swap_b32 v76, v78
    v_mfma_f32_16x16x32_bf16 v[156:159], a[224:227], a[76:79], v[156:159]
    v_permlane16_swap_b32 v77, v79
    buffer_store_dwordx4 v[76:79], v10, s[24:27], s59 offen offset:256 sc1
    ds_read_b64_tr_b16 a[248:249], v24 offset:24576
    ds_read_b64_tr_b16 a[250:251], v24 offset:25088
    s_waitcnt lgkmcnt(10)
    v_mfma_f32_16x16x32_bf16 v[152:155], a[228:231], a[72:75], v[152:155]
    v_cvt_pk_bf16_f32 v84, v84, v85
    v_cvt_pk_bf16_f32 v85, v86, v87
    v_mfma_f32_16x16x32_bf16 v[160:163], a[228:231], a[76:79], v[160:163]
    v_cvt_pk_bf16_f32 v86, v88, v89
    v_cvt_pk_bf16_f32 v87, v90, v91
    ds_read_b64_tr_b16 a[252:253], v25 offset:24576
    ds_read_b64_tr_b16 a[254:255], v25 offset:25088
    s_waitcnt lgkmcnt(10)
    v_mfma_f32_16x16x32_bf16 v[148:151], a[232:235], a[88:91], v[148:151]
    v_permlane32_swap_b32 v84, v86
    v_permlane32_swap_b32 v85, v87
    v_mfma_f32_16x16x32_bf16 v[156:159], a[232:235], a[92:95], v[156:159]
    v_permlane16_swap_b32 v84, v86
    v_permlane16_swap_b32 v85, v87
    s_waitcnt vmcnt(5)
    s_barrier
    ds_read_b64_tr_b16 a[224:225], v24 offset:49152
    ds_read_b64_tr_b16 a[226:227], v24 offset:49664
    s_waitcnt lgkmcnt(10)
    v_mfma_f32_16x16x32_bf16 v[152:155], a[236:239], a[88:91], v[152:155]
    buffer_store_dwordx4 v[84:87], v10, s[24:27], s3 offen offset:0 sc1
    v_cvt_pk_bf16_f32 v92, v92, v93
    v_mfma_f32_16x16x32_bf16 v[160:163], a[236:239], a[92:95], v[160:163]
    v_cvt_pk_bf16_f32 v93, v94, v95
    v_cvt_pk_bf16_f32 v94, v96, v97
    ds_read_b64_tr_b16 a[228:229], v25 offset:49152
    ds_read_b64_tr_b16 a[230:231], v25 offset:49664
    s_waitcnt lgkmcnt(10)
    v_mfma_f32_16x16x32_bf16 v[148:151], a[240:243], a[104:107], v[148:151]
    v_cvt_pk_bf16_f32 v95, v98, v99
    v_permlane32_swap_b32 v92, v94
    v_mfma_f32_16x16x32_bf16 v[156:159], a[240:243], a[108:111], v[156:159]
    v_permlane32_swap_b32 v93, v95
    v_permlane16_swap_b32 v92, v94
    ds_read_b64_tr_b16 a[232:233], v24 offset:57344
    ds_read_b64_tr_b16 a[234:235], v24 offset:57856
    s_waitcnt lgkmcnt(10)
    v_mfma_f32_16x16x32_bf16 v[152:155], a[244:247], a[104:107], v[152:155]
    v_permlane16_swap_b32 v93, v95
    buffer_store_dwordx4 v[92:95], v11, s[24:27], s3 offen offset:0 sc1
    v_mfma_f32_16x16x32_bf16 v[160:163], a[244:247], a[108:111], v[160:163]
    v_cvt_pk_bf16_f32 v100, v100, v101
    v_cvt_pk_bf16_f32 v101, v102, v103
    ds_read_b64_tr_b16 a[236:237], v25 offset:57344
    ds_read_b64_tr_b16 a[238:239], v25 offset:57856
    s_waitcnt lgkmcnt(10)
    v_mfma_f32_16x16x32_bf16 v[148:151], a[248:251], a[120:123], v[148:151]
    v_cvt_pk_bf16_f32 v102, v104, v105
    v_cvt_pk_bf16_f32 v103, v106, v107
    v_mfma_f32_16x16x32_bf16 v[156:159], a[248:251], a[124:127], v[156:159]
    v_permlane32_swap_b32 v100, v102
    v_permlane32_swap_b32 v101, v103
    ds_read_b64_tr_b16 a[240:241], v26 offset:0
    ds_read_b64_tr_b16 a[242:243], v26 offset:512
    s_waitcnt lgkmcnt(10)
    v_mfma_f32_16x16x32_bf16 v[152:155], a[252:255], a[120:123], v[152:155]
    v_permlane16_swap_b32 v100, v102
    v_permlane16_swap_b32 v101, v103
    v_mfma_f32_16x16x32_bf16 v[160:163], a[252:255], a[124:127], v[160:163]
    buffer_store_dwordx4 v[100:103], v10, s[24:27], s3 offen offset:256 sc1
    v_cvt_pk_bf16_f32 v108, v108, v109
    ds_read_b64_tr_b16 a[244:245], v27 offset:0
    ds_read_b64_tr_b16 a[246:247], v27 offset:512
    s_waitcnt lgkmcnt(10)
    v_mfma_f32_16x16x32_bf16 v[148:151], a[224:227], a[136:139], v[148:151]
    v_cvt_pk_bf16_f32 v109, v110, v111
    v_cvt_pk_bf16_f32 v110, v112, v113
    v_mfma_f32_16x16x32_bf16 v[156:159], a[224:227], a[140:143], v[156:159]
    v_cvt_pk_bf16_f32 v111, v114, v115
    v_permlane32_swap_b32 v108, v110
    ds_read_b64_tr_b16 a[248:249], v26 offset:8192
    ds_read_b64_tr_b16 a[250:251], v26 offset:8704
    s_waitcnt lgkmcnt(10)
    v_mfma_f32_16x16x32_bf16 v[152:155], a[228:231], a[136:139], v[152:155]
    v_permlane32_swap_b32 v109, v111
    v_permlane16_swap_b32 v108, v110
    v_mfma_f32_16x16x32_bf16 v[160:163], a[228:231], a[140:143], v[160:163]
    v_permlane16_swap_b32 v109, v111
    buffer_store_dwordx4 v[108:111], v11, s[24:27], s3 offen offset:256 sc1
    ds_read_b64_tr_b16 a[252:253], v27 offset:8192
    ds_read_b64_tr_b16 a[254:255], v27 offset:8704
    s_waitcnt lgkmcnt(10)
    v_mfma_f32_16x16x32_bf16 v[148:151], a[232:235], a[152:155], v[148:151]
    v_cvt_pk_bf16_f32 v116, v116, v117
    v_cvt_pk_bf16_f32 v117, v118, v119
    v_mfma_f32_16x16x32_bf16 v[156:159], a[232:235], a[156:159], v[156:159]
    v_cvt_pk_bf16_f32 v118, v120, v121
    v_cvt_pk_bf16_f32 v119, v122, v123
    ds_read_b64_tr_b16 a[224:225], v26 offset:16384
    ds_read_b64_tr_b16 a[226:227], v26 offset:16896
    s_waitcnt lgkmcnt(10)
    v_mfma_f32_16x16x32_bf16 v[152:155], a[236:239], a[152:155], v[152:155]
    v_permlane32_swap_b32 v116, v118
    v_permlane32_swap_b32 v117, v119
    v_mfma_f32_16x16x32_bf16 v[160:163], a[236:239], a[156:159], v[160:163]
    v_permlane16_swap_b32 v116, v118
    v_permlane16_swap_b32 v117, v119
    ds_read_b64_tr_b16 a[228:229], v27 offset:16384
    ds_read_b64_tr_b16 a[230:231], v27 offset:16896
    s_waitcnt lgkmcnt(10)
    v_mfma_f32_16x16x32_bf16 v[148:151], a[240:243], a[168:171], v[148:151]
    buffer_store_dwordx4 v[116:119], v10, s[24:27], s4 offen offset:0 sc1
    v_cvt_pk_bf16_f32 v124, v124, v125
    v_mfma_f32_16x16x32_bf16 v[156:159], a[240:243], a[172:175], v[156:159]
    v_cvt_pk_bf16_f32 v125, v126, v127
    v_cvt_pk_bf16_f32 v126, v128, v129
    ds_read_b64_tr_b16 a[232:233], v26 offset:24576
    ds_read_b64_tr_b16 a[234:235], v26 offset:25088
    s_waitcnt lgkmcnt(10)
    v_mfma_f32_16x16x32_bf16 v[152:155], a[244:247], a[168:171], v[152:155]
    v_cvt_pk_bf16_f32 v127, v130, v131
    v_permlane32_swap_b32 v124, v126
    v_mfma_f32_16x16x32_bf16 v[160:163], a[244:247], a[172:175], v[160:163]
    v_permlane32_swap_b32 v125, v127
    v_permlane16_swap_b32 v124, v126
    ds_read_b64_tr_b16 a[236:237], v27 offset:24576
    ds_read_b64_tr_b16 a[238:239], v27 offset:25088
    s_waitcnt lgkmcnt(10)
    v_mfma_f32_16x16x32_bf16 v[148:151], a[248:251], a[184:187], v[148:151]
    v_permlane16_swap_b32 v125, v127
    buffer_store_dwordx4 v[124:127], v11, s[24:27], s4 offen offset:0 sc1
    v_mfma_f32_16x16x32_bf16 v[156:159], a[248:251], a[188:191], v[156:159]
    v_cvt_pk_bf16_f32 v132, v132, v133
    v_cvt_pk_bf16_f32 v133, v134, v135
    s_waitcnt lgkmcnt(8)
    v_mfma_f32_16x16x32_bf16 v[152:155], a[252:255], a[184:187], v[152:155]
    v_cvt_pk_bf16_f32 v134, v136, v137
    v_cvt_pk_bf16_f32 v135, v138, v139
    v_mfma_f32_16x16x32_bf16 v[160:163], a[252:255], a[188:191], v[160:163]
    v_permlane32_swap_b32 v132, v134
    v_permlane32_swap_b32 v133, v135
    s_waitcnt lgkmcnt(6)
    v_mfma_f32_16x16x32_bf16 v[148:151], a[224:227], a[200:203], v[148:151]
    v_permlane16_swap_b32 v132, v134
    v_permlane16_swap_b32 v133, v135
    v_mfma_f32_16x16x32_bf16 v[156:159], a[224:227], a[204:207], v[156:159]
    buffer_store_dwordx4 v[132:135], v10, s[24:27], s4 offen offset:256 sc1
    v_cvt_pk_bf16_f32 v140, v140, v141
    s_waitcnt lgkmcnt(4)
    v_mfma_f32_16x16x32_bf16 v[152:155], a[228:231], a[200:203], v[152:155]
    v_cvt_pk_bf16_f32 v141, v142, v143
    v_cvt_pk_bf16_f32 v142, v144, v145
    v_mfma_f32_16x16x32_bf16 v[160:163], a[228:231], a[204:207], v[160:163]
    v_cvt_pk_bf16_f32 v143, v146, v147
    v_permlane32_swap_b32 v140, v142
    s_waitcnt lgkmcnt(2)
    v_mfma_f32_16x16x32_bf16 v[148:151], a[232:235], a[216:219], v[148:151]
    v_permlane32_swap_b32 v141, v143
    v_permlane16_swap_b32 v140, v142
    v_mfma_f32_16x16x32_bf16 v[156:159], a[232:235], a[220:223], v[156:159]
    v_permlane16_swap_b32 v141, v143
    buffer_store_dwordx4 v[140:143], v11, s[24:27], s4 offen offset:256 sc1
    s_waitcnt lgkmcnt(0)
    v_mfma_f32_16x16x32_bf16 v[152:155], a[236:239], a[216:219], v[152:155]
    v_mfma_f32_16x16x32_bf16 v[160:163], a[236:239], a[220:223], v[160:163]
    s_nop 3
    v_cvt_pk_bf16_f32 v148, v148, v149
    v_cvt_pk_bf16_f32 v149, v150, v151
    s_nop 4
    v_cvt_pk_bf16_f32 v150, v152, v153
    v_cvt_pk_bf16_f32 v151, v154, v155
    s_nop 0
    v_permlane32_swap_b32 v148, v150
    v_permlane32_swap_b32 v149, v151
    s_nop 0
    v_permlane16_swap_b32 v148, v150
    v_permlane16_swap_b32 v149, v151
    buffer_store_dwordx4 v[148:151], v10, s[24:27], s5 offen offset:0 sc1
    v_cvt_pk_bf16_f32 v156, v156, v157
    v_cvt_pk_bf16_f32 v157, v158, v159
    v_cvt_pk_bf16_f32 v158, v160, v161
    v_cvt_pk_bf16_f32 v159, v162, v163
    s_nop 0
    v_permlane32_swap_b32 v156, v158
    v_permlane32_swap_b32 v157, v159
    s_nop 0
    v_permlane16_swap_b32 v156, v158
    v_permlane16_swap_b32 v157, v159
    buffer_store_dwordx4 v[156:159], v10, s[24:27], s5 offen offset:256 sc1
    s_waitcnt vmcnt(14)
    ds_read_b128 a[224:227], v36 offset:0
    ds_read_b128 a[228:231], v36 offset:64
    ds_read_b128 a[232:235], v36 offset:128
    ds_read_b128 a[236:239], v36 offset:192
    ds_read_b128 a[240:243], v36 offset:256
    ds_read_b128 a[244:247], v36 offset:320
    s_waitcnt lgkmcnt(5)
    v_mfma_f32_16x16x32_bf16 v[164:167], a[224:227], a[8:11], 0
    v_cmp_gt_i32 s[88:89], 0, v240
    v_cmp_gt_i32 s[90:91], 1, v240
    v_mfma_f32_16x16x32_bf16 v[168:171], a[224:227], a[12:15], 0
    v_cndmask_b32 v52, 0, v241, s[88:89]
    v_cmp_gt_i32 s[88:89], 2, v240
    ds_read_b128 a[248:251], v36 offset:384
    s_waitcnt lgkmcnt(5)
    v_mfma_f32_16x16x32_bf16 v[164:167], a[228:231], a[24:27], v[164:167]
    v_sub_f32_e32 v68, v241, v52
    v_cndmask_b32 v53, 0, v241, s[90:91]
    v_mfma_f32_16x16x32_bf16 v[168:171], a[228:231], a[28:31], v[168:171]
    v_cmp_gt_i32 s[90:91], 3, v240
    v_sub_f32_e64 v69, v241, v53
    ds_read_b128 a[252:255], v36 offset:448
    s_waitcnt lgkmcnt(5)
    v_mfma_f32_16x16x32_bf16 v[164:167], a[232:235], a[40:43], v[164:167]
    v_cndmask_b32 v54, 0, v241, s[88:89]
    v_cmp_gt_i32 s[88:89], 8, v240
    v_mfma_f32_16x16x32_bf16 v[168:171], a[232:235], a[44:47], v[168:171]
    v_sub_f32_e32 v70, v241, v54
    v_cndmask_b32 v55, 0, v241, s[90:91]
    ds_read_b128 a[224:227], v36 offset:512
    s_waitcnt lgkmcnt(5)
    v_mfma_f32_16x16x32_bf16 v[164:167], a[236:239], a[56:59], v[164:167]
    v_cmp_gt_i32 s[90:91], 9, v240
    v_sub_f32_e32 v71, v241, v55
    v_mfma_f32_16x16x32_bf16 v[168:171], a[236:239], a[60:63], v[168:171]
    v_cndmask_b32 v56, 0, v241, s[88:89]
    v_cmp_gt_i32 s[88:89], 10, v240
    ds_read_b128 a[228:231], v36 offset:576
    s_waitcnt lgkmcnt(5)
    v_mfma_f32_16x16x32_bf16 v[164:167], a[240:243], a[72:75], v[164:167]
    v_sub_f32_e32 v72, v241, v56
    v_cndmask_b32 v57, 0, v241, s[90:91]
    v_mfma_f32_16x16x32_bf16 v[168:171], a[240:243], a[76:79], v[168:171]
    v_cmp_gt_i32 s[90:91], 11, v240
    v_sub_f32_e64 v73, v241, v57
    ds_read_b128 a[232:235], v36 offset:640
    s_waitcnt lgkmcnt(5)
    v_mfma_f32_16x16x32_bf16 v[164:167], a[244:247], a[88:91], v[164:167]
    v_cndmask_b32 v58, 0, v241, s[88:89]
    v_cmp_gt_i32 s[88:89], 16, v240
    v_mfma_f32_16x16x32_bf16 v[168:171], a[244:247], a[92:95], v[168:171]
    v_sub_f32_e32 v74, v241, v58
    v_cndmask_b32 v59, 0, v241, s[90:91]
    ds_read_b128 a[236:239], v36 offset:704
    s_waitcnt lgkmcnt(5)
    v_mfma_f32_16x16x32_bf16 v[164:167], a[248:251], a[104:107], v[164:167]
    v_cmp_gt_i32 s[90:91], 17, v240
    v_sub_f32_e32 v75, v241, v59
    v_mfma_f32_16x16x32_bf16 v[168:171], a[248:251], a[108:111], v[168:171]
    v_cndmask_b32 v60, 0, v241, s[88:89]
    v_cmp_gt_i32 s[88:89], 18, v240
    ds_read_b128 a[240:243], v36 offset:768
    s_waitcnt lgkmcnt(5)
    v_mfma_f32_16x16x32_bf16 v[164:167], a[252:255], a[120:123], v[164:167]
    v_sub_f32_e32 v76, v241, v60
    v_cndmask_b32 v61, 0, v241, s[90:91]
    v_mfma_f32_16x16x32_bf16 v[168:171], a[252:255], a[124:127], v[168:171]
    v_cmp_gt_i32 s[90:91], 19, v240
    v_sub_f32_e64 v77, v241, v61
    ds_read_b128 a[244:247], v36 offset:832
    s_waitcnt lgkmcnt(5)
    v_mfma_f32_16x16x32_bf16 v[164:167], a[224:227], a[136:139], v[164:167]
    v_cndmask_b32 v62, 0, v241, s[88:89]
    v_cmp_gt_i32 s[88:89], 24, v240
    v_mfma_f32_16x16x32_bf16 v[168:171], a[224:227], a[140:143], v[168:171]
    v_sub_f32_e32 v78, v241, v62
    v_cndmask_b32 v63, 0, v241, s[90:91]
    s_waitcnt lgkmcnt(4)
    v_mfma_f32_16x16x32_bf16 v[164:167], a[228:231], a[152:155], v[164:167]
    v_cmp_gt_i32 s[90:91], 25, v240
    v_sub_f32_e32 v79, v241, v63
    v_mfma_f32_16x16x32_bf16 v[168:171], a[228:231], a[156:159], v[168:171]
    v_cndmask_b32 v64, 0, v241, s[88:89]
    v_cmp_gt_i32 s[88:89], 26, v240
    s_waitcnt lgkmcnt(3)
    v_mfma_f32_16x16x32_bf16 v[164:167], a[232:235], a[168:171], v[164:167]
    v_sub_f32_e32 v80, v241, v64
    v_cndmask_b32 v65, 0, v241, s[90:91]
    v_mfma_f32_16x16x32_bf16 v[168:171], a[232:235], a[172:175], v[168:171]
    v_cmp_gt_i32 s[90:91], 27, v240
    v_sub_f32_e64 v81, v241, v65
    s_waitcnt lgkmcnt(2)
    v_mfma_f32_16x16x32_bf16 v[164:167], a[236:239], a[184:187], v[164:167]
    v_cndmask_b32 v66, 0, v241, s[88:89]
    v_sub_f32_e32 v82, v241, v66
    v_mfma_f32_16x16x32_bf16 v[168:171], a[236:239], a[188:191], v[168:171]
    v_cndmask_b32 v67, 0, v241, s[90:91]
    v_sub_f32_e64 v83, v241, v67
    s_waitcnt lgkmcnt(1)
    v_mfma_f32_16x16x32_bf16 v[164:167], a[240:243], a[200:203], v[164:167]
    v_mfma_f32_16x16x32_bf16 v[168:171], a[240:243], a[204:207], v[168:171]
    s_waitcnt lgkmcnt(0)
    v_mfma_f32_16x16x32_bf16 v[164:167], a[244:247], a[216:219], v[164:167]
    v_mfma_f32_16x16x32_bf16 v[168:171], a[244:247], a[220:223], v[168:171]
    v_and_b32_e64 v38, 16, v0
    v_cmp_eq_u32 vcc, 0, v38
    s_nop 9
    v_cndmask_b32 v38, v168, v164, vcc
L_v_done:
    s_waitcnt vmcnt(0)
    s_barrier
    s_cmp_eq_u32 s44, 0
    s_cbranch_scc0 L_nofl14
    v_mov_b32_e32 v33, s57
    s_mov_b32 exec_hi, 0
    buffer_store_dword v33, v50, s[24:27], 0 offen offset:0 sc1
    s_mov_b64 exec, -1
L_nofl14:
    s_mov_b64 exec, s[64:65]
    buffer_load_dword v48, v51, s[24:27], 0 offen sc1
    s_mov_b64 exec, -1
    s_waitcnt vmcnt(0)
    v_cmp_ne_u32 vcc, s57, v48
    s_nop 1
    s_and_b64 vcc, vcc, s[64:65]
    s_cbranch_scc0 L_pok15
    s_mov_b32 s84, 0
L_psp15:
    s_sleep 2
    s_mov_b64 exec, s[64:65]
    buffer_load_dword v48, v51, s[24:27], 0 offen sc1
    s_mov_b64 exec, -1
    s_add_u32 s84, s84, 1
    s_cmp_gt_u32 s84, 1048576
    s_cbranch_scc1 L_exit
    s_waitcnt vmcnt(0)
    v_cmp_ne_u32 vcc, s57, v48
    s_nop 1
    s_and_b64 vcc, vcc, s[64:65]
    s_cbranch_scc1 L_psp15
L_pok15:
    s_mul_i32 s86, s44, 6144
    s_add_u32 m0, s86, 0
    buffer_load_dwordx4 v[212:215], v1, s[24:27], s73 offen offset:0 sc1
    buffer_load_dwordx4 v1, s[24:27], s70 offen offset:0 sc1 lds
    buffer_load_dwordx4 v1, s[24:27], s70 offen offset:1024 sc1 lds
    s_add_u32 m0, s86, 2048
    buffer_load_dwordx4 v[216:219], v1, s[24:27], s73 offen offset:1024 sc1
    buffer_load_dwordx4 v1, s[24:27], s71 offen offset:0 sc1 lds
    buffer_load_dwordx4 v1, s[24:27], s71 offen offset:1024 sc1 lds
    s_add_u32 m0, s86, 4096
    s_nop 0
    buffer_load_dwordx4 v1, s[24:27], s72 offen offset:0 sc1 lds
    buffer_load_dwordx4 v1, s[24:27], s72 offen offset:1024 sc1 lds
    s_add_u32 m0, s81, 0
    s_nop 0
    buffer_load_dwordx4 v247, s[28:31], s77 offen offset:0 lds
    buffer_load_dwordx4 v248, s[28:31], s77 offen offset:1024 lds
    s_add_u32 m0, s81, 2048
    s_add_u32 s77, s77, 14336
    buffer_load_dwordx4 v247, s[28:31], s77 offen offset:0 lds
    buffer_load_dwordx4 v248, s[28:31], s77 offen offset:1024 lds
    s_add_u32 m0, s81, 4096
    s_add_u32 s77, s77, 14336
    buffer_load_dwordx4 v247, s[28:31], s77 offen offset:0 lds
    buffer_load_dwordx4 v248, s[28:31], s77 offen offset:1024 lds
    s_add_u32 m0, s81, 6144
    s_add_u32 s77, s77, 14336
    buffer_load_dwordx4 v247, s[28:31], s77 offen offset:0 lds
    buffer_load_dwordx4 v248, s[28:31], s77 offen offset:1024 lds
    s_add_u32 m0, s81, 8192
    s_add_u32 s77, s77, 14336
    buffer_load_dwordx4 v247, s[28:31], s77 offen offset:0 lds
    buffer_load_dwordx4 v248, s[28:31], s77 offen offset:1024 lds
    s_add_u32 m0, s81, 10240
    s_add_u32 s77, s77, 14336
    buffer_load_dwordx4 v247, s[28:31], s77 offen offset:0 lds
    buffer_load_dwordx4 v248, s[28:31], s77 offen offset:1024 lds
    s_add_u32 m0, s81, 12288
    s_add_u32 s77, s77, 14336
    buffer_load_dwordx4 v247, s[28:31], s77 offen offset:0 lds
    buffer_load_dwordx4 v248, s[28:31], s77 offen offset:1024 lds
    s_add_u32 m0, s81, 14336
    s_add_u32 s77, s77, 14336
    buffer_load_dwordx4 v247, s[28:31], s77 offen offset:0 lds
    buffer_load_dwordx4 v248, s[28:31], s77 offen offset:1024 lds
    s_waitcnt vmcnt(14)
    ds_read_b64_tr_b16 a[0:1], v251 offset:0
    ds_read_b64_tr_b16 a[2:3], v251 offset:512
    ds_read_b64_tr_b16 a[4:5], v252 offset:0
    ds_read_b64_tr_b16 a[6:7], v252 offset:512
    s_waitcnt vmcnt(12)
    ds_read_b64_tr_b16 a[8:9], v251 offset:2048
    ds_read_b64_tr_b16 a[10:11], v251 offset:2560
    ds_read_b64_tr_b16 a[12:13], v252 offset:2048
    ds_read_b64_tr_b16 a[14:15], v252 offset:2560
    s_waitcnt lgkmcnt(4)
    s_add_u32 m0, s81, 0
    s_add_u32 s77, s77, 14336
    buffer_load_dwordx4 v247, s[28:31], s77 offen offset:0 lds
    buffer_load_dwordx4 v248, s[28:31], s77 offen offset:1024 lds
    s_waitcnt vmcnt(12)
    ds_read_b64_tr_b16 a[16:17], v251 offset:4096
    ds_read_b64_tr_b16 a[18:19], v251 offset:4608
    ds_read_b64_tr_b16 a[20:21], v252 offset:4096
    ds_read_b64_tr_b16 a[22:23], v252 offset:4608
    s_waitcnt lgkmcnt(4)
    s_add_u32 m0, s81, 2048
    s_add_u32 s77, s77, 14336
    buffer_load_dwordx4 v247, s[28:31], s77 offen offset:0 lds
    buffer_load_dwordx4 v248, s[28:31], s77 offen offset:1024 lds
    s_waitcnt lgkmcnt(0)
    s_add_u32 m0, s81, 4096
    s_add_u32 s77, s77, 14336
    buffer_load_dwordx4 v247, s[28:31], s77 offen offset:0 lds
    buffer_load_dwordx4 v248, s[28:31], s77 offen offset:1024 lds
    s_waitcnt vmcnt(14)
    ds_read_b64_tr_b16 a[24:25], v251 offset:6144
    ds_read_b64_tr_b16 a[26:27], v251 offset:6656
    ds_read_b64_tr_b16 a[28:29], v252 offset:6144
    ds_read_b64_tr_b16 a[30:31], v252 offset:6656
    s_waitcnt lgkmcnt(0)
    s_add_u32 m0, s81, 6144
    s_add_u32 s77, s77, 14336
    buffer_load_dwordx4 v247, s[28:31], s77 offen offset:0 lds
    buffer_load_dwordx4 v248, s[28:31], s77 offen offset:1024 lds
    s_waitcnt vmcnt(14)
    ds_read_b64_tr_b16 a[32:33], v251 offset:8192
    ds_read_b64_tr_b16 a[34:35], v251 offset:8704
    ds_read_b64_tr_b16 a[36:37], v252 offset:8192
    ds_read_b64_tr_b16 a[38:39], v252 offset:8704
    s_waitcnt lgkmcnt(0)
    s_add_u32 m0, s81, 8192
    s_add_u32 s77, s77, 14336
    buffer_load_dwordx4 v247, s[28:31], s77 offen offset:0 lds
    buffer_load_dwordx4 v248, s[28:31], s77 offen offset:1024 lds
    s_waitcnt vmcnt(14)
    ds_read_b64_tr_b16 a[40:41], v251 offset:10240
    ds_read_b64_tr_b16 a[42:43], v251 offset:10752
    ds_read_b64_tr_b16 a[44:45], v252 offset:10240
    ds_read_b64_tr_b16 a[46:47], v252 offset:10752
    s_waitcnt vmcnt(12)
    ds_read_b64_tr_b16 a[48:49], v251 offset:12288
    ds_read_b64_tr_b16 a[50:51], v251 offset:12800
    ds_read_b64_tr_b16 a[52:53], v252 offset:12288
    ds_read_b64_tr_b16 a[54:55], v252 offset:12800
    s_waitcnt lgkmcnt(4)
    s_add_u32 m0, s81, 10240
    s_add_u32 s77, s77, 14336
    buffer_load_dwordx4 v247, s[28:31], s77 offen offset:0 lds
    buffer_load_dwordx4 v248, s[28:31], s77 offen offset:1024 lds
    s_waitcnt vmcnt(12)
    ds_read_b64_tr_b16 a[56:57], v251 offset:14336
    ds_read_b64_tr_b16 a[58:59], v251 offset:14848
    ds_read_b64_tr_b16 a[60:61], v252 offset:14336
    ds_read_b64_tr_b16 a[62:63], v252 offset:14848
    s_waitcnt lgkmcnt(4)
    s_add_u32 m0, s81, 12288
    s_add_u32 s77, s77, 14336
    buffer_load_dwordx4 v247, s[28:31], s77 offen offset:0 lds
    buffer_load_dwordx4 v248, s[28:31], s77 offen offset:1024 lds
    s_waitcnt lgkmcnt(0)
    s_add_u32 m0, s81, 14336
    s_add_u32 s77, s77, 14336
    buffer_load_dwordx4 v247, s[28:31], s77 offen offset:0 lds
    buffer_load_dwordx4 v248, s[28:31], s77 offen offset:1024 lds
    s_mov_b64 exec, s[66:67]
    buffer_load_dword v48, v51, s[24:27], 0 offen sc1
    s_mov_b64 exec, -1
    s_waitcnt vmcnt(0)
    v_cmp_ne_u32 vcc, s57, v48
    s_nop 1
    s_and_b64 vcc, vcc, s[66:67]
    s_cbranch_scc0 L_pok16
    s_mov_b32 s84, 0
L_psp16:
    s_sleep 2
    s_mov_b64 exec, s[66:67]
    buffer_load_dword v48, v51, s[24:27], 0 offen sc1
    s_mov_b64 exec, -1
    s_add_u32 s84, s84, 1
    s_cmp_gt_u32 s84, 1048576
    s_cbranch_scc1 L_exit
    s_waitcnt vmcnt(0)
    v_cmp_ne_u32 vcc, s57, v48
    s_nop 1
    s_and_b64 vcc, vcc, s[66:67]
    s_cbranch_scc1 L_psp16
L_pok16:
    s_mul_i32 s86, s44, 6144
    s_add_u32 m0, s86, 24576
    s_add_u32 s87, s70, 28672
    buffer_load_dwordx4 v228, s[24:27], s87 offen offset:0 sc1 lds
    buffer_load_dwordx4 v229, s[24:27], s87 offen offset:1024 sc1 lds
    s_add_u32 m0, s86, 26624
    s_add_u32 s87, s71, 28672
    buffer_load_dwordx4 v228, s[24:27], s87 offen offset:0 sc1 lds
    buffer_load_dwordx4 v229, s[24:27], s87 offen offset:1024 sc1 lds
    s_add_u32 m0, s86, 28672
    s_add_u32 s87, s72, 28672
    buffer_load_dwordx4 v228, s[24:27], s87 offen offset:0 sc1 lds
    buffer_load_dwordx4 v229, s[24:27], s87 offen offset:1024 sc1 lds
    ds_write_b64 v226, v[220:221]
    ds_write_b64 v227, v[222:223] offset:4096
    v_bfi_b32 v212, v30, v212, v224
    v_and_b32_e32 v213, v30, v213
    v_bfi_b32 v218, v32, v218, v224
    v_and_b32_e64 v219, v32, v219
    s_waitcnt lgkmcnt(0)
    s_barrier
    ds_read_b128 v[12:15], v236 offset:16384
    ds_read_b128 v[16:19], v236 offset:17408
    ds_read_b128 v[20:23], v236 offset:0
    ds_read_b128 v[24:27], v236 offset:1024
    s_waitcnt lgkmcnt(3)
    v_mfma_f32_32x32x16_bf16 v[52:67], v[12:15], v[212:215], v[52:67]
    ds_read_b128 v[2:5], v236 offset:14336
    ds_read_b128 v[6:9], v236 offset:15360
    s_waitcnt lgkmcnt(4)
    v_mfma_f32_32x32x16_bf16 v[52:67], v[16:19], v[216:219], v[52:67]
    s_waitcnt lgkmcnt(3)
    v_mfma_f32_32x32x16_bf16 v[68:83], v[20:23], v[212:215], v[68:83]
    ds_read_b128 v[12:15], v236 offset:12288
    ds_read_b128 v[16:19], v236 offset:13312
    s_waitcnt lgkmcnt(4)
    v_mfma_f32_32x32x16_bf16 v[68:83], v[24:27], v[216:219], v[68:83]
    s_nop 5
    v_max_f32_e32 v240, v52, v53
    v_max_f32_e64 v241, v54, v55
    v_max3_f32 v240, v240, v56, v57
    v_max3_f32 v241, v241, v58, v59
    v_max3_f32 v240, v240, v60, v61
    s_waitcnt lgkmcnt(3)
    v_mfma_f32_32x32x16_bf16 v[84:99], v[2:5], v[212:215], 0
    ds_read_b128 v[20:23], v236 offset:10240
    ds_read_b128 v[24:27], v236 offset:11264
    v_max3_f32 v241, v241, v62, v63
    v_max3_f32 v240, v240, v64, v65
    v_max3_f32 v241, v241, v66, v67
    s_waitcnt lgkmcnt(4)
    v_mfma_f32_32x32x16_bf16 v[84:99], v[6:9], v[216:219], v[84:99]
    v_max3_f32 v240, v240, v68, v69
    v_max3_f32 v241, v241, v70, v71
    v_max3_f32 v240, v240, v72, v73
    v_max3_f32 v241, v241, v74, v75
    v_max3_f32 v240, v240, v76, v77
    s_waitcnt lgkmcnt(3)
    v_mfma_f32_32x32x16_bf16 v[100:115], v[12:15], v[212:215], 0
    ds_read_b128 v[2:5], v236 offset:8192
    ds_read_b128 v[6:9], v236 offset:9216
    v_max3_f32 v241, v241, v78, v79
    v_max3_f32 v240, v240, v80, v81
    v_max3_f32 v241, v241, v82, v83
    s_waitcnt lgkmcnt(4)
    v_mfma_f32_32x32x16_bf16 v[100:115], v[16:19], v[216:219], v[100:115]
    v_max3_f32 v240, v240, v84, v85
    v_max3_f32 v241, v241, v86, v87
    v_max3_f32 v240, v240, v88, v89
    v_max3_f32 v241, v241, v90, v91
    v_max3_f32 v240, v240, v92, v93
    s_waitcnt lgkmcnt(3)
    v_mfma_f32_32x32x16_bf16 v[116:131], v[20:23], v[212:215], 0
    ds_read_b128 v[12:15], v236 offset:6144
    ds_read_b128 v[16:19], v236 offset:7168
    v_max3_f32 v241, v241, v94, v95
    v_max3_f32 v240, v240, v96, v97
    v_max3_f32 v241, v241, v98, v99
    s_waitcnt lgkmcnt(4)
    v_mfma_f32_32x32x16_bf16 v[116:131], v[24:27], v[216:219], v[116:131]
    v_max3_f32 v240, v240, v100, v101
    v_max3_f32 v241, v241, v102, v103
    v_max3_f32 v240, v240, v104, v105
    v_max3_f32 v241, v241, v106, v107
    v_max3_f32 v240, v240, v108, v109
    s_waitcnt lgkmcnt(3)
    v_mfma_f32_32x32x16_bf16 v[132:147], v[2:5], v[212:215], 0
    ds_read_b128 v[20:23], v236 offset:4096
    ds_read_b128 v[24:27], v236 offset:5120
    v_max3_f32 v241, v241, v110, v111
    v_max3_f32 v240, v240, v112, v113
    v_max3_f32 v241, v241, v114, v115
    s_waitcnt lgkmcnt(4)
    v_mfma_f32_32x32x16_bf16 v[132:147], v[6:9], v[216:219], v[132:147]
    v_max3_f32 v240, v240, v116, v117
    v_max3_f32 v241, v241, v118, v119
    v_max3_f32 v240, v240, v120, v121
    v_max3_f32 v241, v241, v122, v123
    v_max3_f32 v240, v240, v124, v125
    s_add_u32 m0, s80, 0
    s_add_u32 s77, s77, 14336
    buffer_load_dwordx4 v247, s[28:31], s77 offen offset:0 lds
    s_waitcnt lgkmcnt(3)
    v_mfma_f32_32x32x16_bf16 v[148:163], v[12:15], v[212:215], 0
    ds_read_b128 v[2:5], v236 offset:2048
    ds_read_b128 v[6:9], v236 offset:3072
    v_max3_f32 v241, v241, v126, v127
    v_max3_f32 v240, v240, v128, v129
    v_max3_f32 v241, v241, v130, v131
    s_waitcnt lgkmcnt(4)
    v_mfma_f32_32x32x16_bf16 v[148:163], v[16:19], v[216:219], v[148:163]
    buffer_store_dword v38, v37, s[24:27], s74 offen sc1
    v_max3_f32 v240, v240, v132, v133
    v_max3_f32 v241, v241, v134, v135
    v_max3_f32 v240, v240, v136, v137
    v_max3_f32 v241, v241, v138, v139
    v_max3_f32 v240, v240, v140, v141
    s_waitcnt lgkmcnt(3)
    v_mfma_f32_32x32x16_bf16 v[164:179], v[20:23], v[212:215], 0
    v_max3_f32 v241, v241, v142, v143
    v_max3_f32 v240, v240, v144, v145
    v_max3_f32 v241, v241, v146, v147
    s_waitcnt lgkmcnt(2)
    v_mfma_f32_32x32x16_bf16 v[164:179], v[24:27], v[216:219], v[164:179]
    v_max3_f32 v240, v240, v148, v149
    v_max3_f32 v241, v241, v150, v151
    v_max3_f32 v240, v240, v152, v153
    v_max3_f32 v241, v241, v154, v155
    v_max3_f32 v240, v240, v156, v157
    s_waitcnt lgkmcnt(1)
    v_mfma_f32_32x32x16_bf16 v[180:195], v[2:5], v[212:215], 0
    v_max3_f32 v241, v241, v158, v159
    v_max3_f32 v240, v240, v160, v161
    v_max3_f32 v241, v241, v162, v163
    s_waitcnt lgkmcnt(0)
    v_mfma_f32_32x32x16_bf16 v[180:195], v[6:9], v[216:219], v[180:195]
    v_max3_f32 v240, v240, v164, v165
    v_max3_f32 v241, v241, v166, v167
    v_max3_f32 v240, v240, v168, v169
    v_max3_f32 v241, v241, v170, v171
    v_max3_f32 v240, v240, v172, v173
    v_max3_f32 v241, v241, v174, v175
    v_max3_f32 v240, v240, v176, v177
    v_max3_f32 v241, v241, v178, v179
    buffer_load_dwordx4 v248, s[28:31], s77 offen offset:1024 lds
    s_waitcnt vmcnt(3)
    ds_write_b64 v226, v[224:225] offset:24576
    ds_write_b64 v227, v[224:225] offset:28672
    v_max3_f32 v240, v240, v180, v181
    v_max3_f32 v241, v241, v182, v183
    v_max3_f32 v240, v240, v184, v185
    v_max3_f32 v241, v241, v186, v187
    v_max3_f32 v240, v240, v188, v189
    v_max3_f32 v241, v241, v190, v191
    v_max3_f32 v240, v240, v192, v193
    v_max3_f32 v241, v241, v194, v195
    s_waitcnt lgkmcnt(0)
    s_barrier
L_join:
    ds_read_b64_tr_b16 v[12:13], v237 offset:16384
    ds_read_b64_tr_b16 v[14:15], v238 offset:16384
    ds_read_b64_tr_b16 v[16:17], v237 offset:16640
    ds_read_b64_tr_b16 v[18:19], v238 offset:16640
    v_max_f32_e64 v240, v240, v241
    v_mov_b32_e64 v241, v240
    s_nop 1
    v_permlane32_swap_b32 v240, v241
    v_max_f32_e64 v240, v240, v241
    v_mul_f32_e64 v240, s63, v240
    s_mov_b32 s64, 0x1ffff
    s_mov_b32 s65, 0
    v_pk_fma_f32 v[52:53], v[52:53], s[62:63], v[240:241] op_sel:[0,1,0] op_sel_hi:[1,1,0] neg_lo:[0,0,1] neg_hi:[0,0,1]
    s_add_u32 m0, s80, 2048
    s_add_u32 s77, s77, 14336
    v_pk_fma_f32 v[54:55], v[54:55], s[62:63], v[240:241] op_sel:[0,1,0] op_sel_hi:[1,1,0] neg_lo:[0,0,1] neg_hi:[0,0,1]
    buffer_load_dwordx4 v247, s[28:31], s77 offen offset:0 lds
    v_pk_fma_f32 v[56:57], v[56:57], s[62:63], v[240:241] op_sel:[0,1,0] op_sel_hi:[1,1,0] neg_lo:[0,0,1] neg_hi:[0,0,1]
    buffer_load_dwordx4 v248, s[28:31], s77 offen offset:1024 lds
    v_pk_fma_f32 v[58:59], v[58:59], s[62:63], v[240:241] op_sel:[0,1,0] op_sel_hi:[1,1,0] neg_lo:[0,0,1] neg_hi:[0,0,1]
    v_pk_fma_f32 v[60:61], v[60:61], s[62:63], v[240:241] op_sel:[0,1,0] op_sel_hi:[1,1,0] neg_lo:[0,0,1] neg_hi:[0,0,1]
    v_pk_fma_f32 v[62:63], v[62:63], s[62:63], v[240:241] op_sel:[0,1,0] op_sel_hi:[1,1,0] neg_lo:[0,0,1] neg_hi:[0,0,1]
    v_pk_fma_f32 v[64:65], v[64:65], s[62:63], v[240:241] op_sel:[0,1,0] op_sel_hi:[1,1,0] neg_lo:[0,0,1] neg_hi:[0,0,1]
    v_pk_fma_f32 v[66:67], v[66:67], s[62:63], v[240:241] op_sel:[0,1,0] op_sel_hi:[1,1,0] neg_lo:[0,0,1] neg_hi:[0,0,1]
    v_exp_f32_e32 v52, v52
    s_add_u32 m0, s80, 4096
    s_add_u32 s77, s77, 14336
    v_exp_f32_e64 v53, v53
    buffer_load_dwordx4 v247, s[28:31], s77 offen offset:0 lds
    v_exp_f32_e64 v54, v54
    v_exp_f32_e64 v55, v55
    v_exp_f32_e64 v56, v56
    v_exp_f32_e64 v57, v57
    v_exp_f32_e64 v58, v58
    v_exp_f32_e64 v59, v59
    buffer_load_dwordx4 v248, s[28:31], s77 offen offset:1024 lds
    v_exp_f32_e64 v60, v60
    v_exp_f32_e64 v61, v61
    ds_read_b64_tr_b16 v[20:21], v237 offset:14336
    v_exp_f32_e64 v62, v62
    ds_read_b64_tr_b16 v[22:23], v238 offset:14336
    v_exp_f32_e64 v63, v63
    ds_read_b64_tr_b16 v[24:25], v237 offset:14592
    v_exp_f32_e64 v64, v64
    ds_read_b64_tr_b16 v[26:27], v238 offset:14592
    v_exp_f32_e64 v65, v65
    s_add_u32 m0, s80, 6144
    s_add_u32 s77, s77, 14336
    v_exp_f32_e64 v66, v66
    buffer_load_dwordx4 v247, s[28:31], s77 offen offset:0 lds
    v_exp_f32_e64 v67, v67
    v_cvt_pk_bf16_f32 v220, v52, v53
    v_cvt_pk_bf16_f32 v221, v54, v55
    v_cvt_pk_bf16_f32 v222, v56, v57
    v_cvt_pk_bf16_f32 v223, v58, v59
    v_cvt_pk_bf16_f32 v224, v60, v61
    v_cvt_pk_bf16_f32 v225, v62, v63
    v_cvt_pk_bf16_f32 v226, v64, v65
    v_cvt_pk_bf16_f32 v227, v66, v67
    s_waitcnt vmcnt(6)
    s_barrier
    s_cmp_eq_u32 s44, 0
    s_cbranch_scc0 L_nofl17
    v_mov_b32_e64 v33, s57
    s_mov_b32 exec_hi, 0
    buffer_store_dword v33, v50, s[24:27], 0 offen offset:128 sc1
    s_mov_b64 exec, -1
L_nofl17:
    v_pk_fma_f32 v[84:85], v[84:85], s[62:63], v[240:241] op_sel:[0,1,0] op_sel_hi:[1,1,0] neg_lo:[0,0,1] neg_hi:[0,0,1]
    buffer_load_dwordx4 v248, s[28:31], s77 offen offset:1024 lds
    v_pk_fma_f32 v[86:87], v[86:87], s[62:63], v[240:241] op_sel:[0,1,0] op_sel_hi:[1,1,0] neg_lo:[0,0,1] neg_hi:[0,0,1]
    v_pk_fma_f32 v[88:89], v[88:89], s[62:63], v[240:241] op_sel:[0,1,0] op_sel_hi:[1,1,0] neg_lo:[0,0,1] neg_hi:[0,0,1]
    v_pk_fma_f32 v[90:91], v[90:91], s[62:63], v[240:241] op_sel:[0,1,0] op_sel_hi:[1,1,0] neg_lo:[0,0,1] neg_hi:[0,0,1]
    v_pk_fma_f32 v[92:93], v[92:93], s[62:63], v[240:241] op_sel:[0,1,0] op_sel_hi:[1,1,0] neg_lo:[0,0,1] neg_hi:[0,0,1]
    v_pk_fma_f32 v[94:95], v[94:95], s[62:63], v[240:241] op_sel:[0,1,0] op_sel_hi:[1,1,0] neg_lo:[0,0,1] neg_hi:[0,0,1]
    v_pk_fma_f32 v[96:97], v[96:97], s[62:63], v[240:241] op_sel:[0,1,0] op_sel_hi:[1,1,0] neg_lo:[0,0,1] neg_hi:[0,0,1]
    v_pk_fma_f32 v[98:99], v[98:99], s[62:63], v[240:241] op_sel:[0,1,0] op_sel_hi:[1,1,0] neg_lo:[0,0,1] neg_hi:[0,0,1]
    v_exp_f32_e64 v84, v84
    v_exp_f32_e64 v85, v85
    s_waitcnt lgkmcnt(6)
    v_mfma_f32_32x32x16_bf16 v[196:211], v[12:15], v[220:223], 0
    s_add_u32 m0, s80, 8192
    s_add_u32 s77, s77, 14336
    v_exp_f32_e32 v86, v86
    buffer_load_dwordx4 v247, s[28:31], s77 offen offset:0 lds
    v_exp_f32_e64 v87, v87
    v_exp_f32_e64 v88, v88
    v_exp_f32_e64 v89, v89
    v_exp_f32_e64 v90, v90
    s_waitcnt lgkmcnt(4)
    v_mfma_f32_32x32x16_bf16 v[196:211], v[16:19], v[224:227], v[196:211]
    buffer_load_dwordx4 v248, s[28:31], s77 offen offset:1024 lds
    v_exp_f32_e32 v91, v91
    ds_read_b64_tr_b16 a[64:65], v251 offset:0
    v_exp_f32_e64 v92, v92
    ds_read_b64_tr_b16 a[66:67], v251 offset:512
    v_exp_f32_e64 v93, v93
    ds_read_b64_tr_b16 a[68:69], v252 offset:0
    ds_read_b64_tr_b16 v[12:13], v237 offset:12288
    ds_read_b64_tr_b16 a[70:71], v252 offset:512
    v_exp_f32_e64 v94, v94
    ds_read_b64_tr_b16 v[14:15], v238 offset:12288
    v_exp_f32_e64 v95, v95
    s_add_u32 m0, s80, 10240
    s_add_u32 s77, s77, 14336
    ds_read_b64_tr_b16 v[16:17], v237 offset:12544
    buffer_load_dwordx4 v247, s[28:31], s77 offen offset:0 lds
    v_exp_f32_e64 v96, v96
    ds_read_b64_tr_b16 v[18:19], v238 offset:12544
    v_exp_f32_e64 v97, v97
    v_exp_f32_e64 v98, v98
    v_exp_f32_e64 v99, v99
    v_cvt_pk_bf16_f32 v228, v84, v85
    v_cvt_pk_bf16_f32 v229, v86, v87
    v_cvt_pk_bf16_f32 v230, v88, v89
    buffer_load_dwordx4 v248, s[28:31], s77 offen offset:1024 lds
    v_cvt_pk_bf16_f32 v231, v90, v91
    ds_read_b64_tr_b16 a[72:73], v251 offset:2048
    v_cvt_pk_bf16_f32 v232, v92, v93
    ds_read_b64_tr_b16 a[74:75], v251 offset:2560
    v_cvt_pk_bf16_f32 v233, v94, v95
    ds_read_b64_tr_b16 a[76:77], v252 offset:2048
    v_cvt_pk_bf16_f32 v234, v96, v97
    ds_read_b64_tr_b16 a[78:79], v252 offset:2560
    v_cvt_pk_bf16_f32 v235, v98, v99
    v_pk_fma_f32 v[100:101], v[100:101], s[62:63], v[240:241] op_sel:[0,1,0] op_sel_hi:[1,1,0] neg_lo:[0,0,1] neg_hi:[0,0,1]
    v_pk_fma_f32 v[102:103], v[102:103], s[62:63], v[240:241] op_sel:[0,1,0] op_sel_hi:[1,1,0] neg_lo:[0,0,1] neg_hi:[0,0,1]
    v_pk_fma_f32 v[104:105], v[104:105], s[62:63], v[240:241] op_sel:[0,1,0] op_sel_hi:[1,1,0] neg_lo:[0,0,1] neg_hi:[0,0,1]
    v_pk_fma_f32 v[106:107], v[106:107], s[62:63], v[240:241] op_sel:[0,1,0] op_sel_hi:[1,1,0] neg_lo:[0,0,1] neg_hi:[0,0,1]
    v_pk_fma_f32 v[108:109], v[108:109], s[62:63], v[240:241] op_sel:[0,1,0] op_sel_hi:[1,1,0] neg_lo:[0,0,1] neg_hi:[0,0,1]
    v_pk_fma_f32 v[110:111], v[110:111], s[62:63], v[240:241] op_sel:[0,1,0] op_sel_hi:[1,1,0] neg_lo:[0,0,1] neg_hi:[0,0,1]
    v_pk_fma_f32 v[112:113], v[112:113], s[62:63], v[240:241] op_sel:[0,1,0] op_sel_hi:[1,1,0] neg_lo:[0,0,1] neg_hi:[0,0,1]
    s_waitcnt lgkmcnt(7)
    s_add_u32 m0, s81, 0
    s_add_u32 s77, s77, 14336
    v_pk_fma_f32 v[114:115], v[114:115], s[62:63], v[240:241] op_sel:[0,1,0] op_sel_hi:[1,1,0] neg_lo:[0,0,1] neg_hi:[0,0,1]
    buffer_load_dwordx4 v247, s[28:31], s77 offen offset:0 lds
    v_exp_f32_e64 v100, v100
    v_exp_f32_e64 v101, v101
    v_mfma_f32_32x32x16_bf16 v[196:211], v[20:23], v[228:231], v[196:211]
    v_exp_f32_e64 v102, v102
    v_exp_f32_e64 v103, v103
    v_exp_f32_e64 v104, v104
    buffer_load_dwordx4 v248, s[28:31], s77 offen offset:1024 lds
    v_exp_f32_e64 v105, v105
    ds_read_b64_tr_b16 a[80:81], v251 offset:4096
    v_exp_f32_e64 v106, v106
    ds_read_b64_tr_b16 a[82:83], v251 offset:4608
    v_mfma_f32_32x32x16_bf16 v[196:211], v[24:27], v[232:235], v[196:211]
    ds_read_b64_tr_b16 a[84:85], v252 offset:4096
    v_exp_f32_e64 v107, v107
    ds_read_b64_tr_b16 a[86:87], v252 offset:4608
    v_exp_f32_e64 v108, v108
    v_exp_f32_e64 v109, v109
    s_waitcnt lgkmcnt(4)
    s_add_u32 m0, s81, 2048
    s_add_u32 s77, s77, 14336
    ds_read_b64_tr_b16 v[20:21], v237 offset:10240
    buffer_load_dwordx4 v247, s[28:31], s77 offen offset:0 lds
    v_exp_f32_e32 v110, v110
    ds_read_b64_tr_b16 v[22:23], v238 offset:10240
    v_exp_f32_e64 v111, v111
    ds_read_b64_tr_b16 v[24:25], v237 offset:10496
    v_exp_f32_e64 v112, v112
    ds_read_b64_tr_b16 v[26:27], v238 offset:10496
    v_exp_f32_e64 v113, v113
    v_exp_f32_e64 v114, v114
    buffer_load_dwordx4 v248, s[28:31], s77 offen offset:1024 lds
    v_exp_f32_e64 v115, v115
    ds_read_b64_tr_b16 a[88:89], v251 offset:6144
    v_cvt_pk_bf16_f32 v220, v100, v101
    ds_read_b64_tr_b16 a[90:91], v251 offset:6656
    v_cvt_pk_bf16_f32 v221, v102, v103
    ds_read_b64_tr_b16 a[92:93], v252 offset:6144
    v_cvt_pk_bf16_f32 v222, v104, v105
    ds_read_b64_tr_b16 a[94:95], v252 offset:6656
    v_cvt_pk_bf16_f32 v223, v106, v107
    v_cvt_pk_bf16_f32 v224, v108, v109
    v_cvt_pk_bf16_f32 v225, v110, v111
    v_cvt_pk_bf16_f32 v226, v112, v113
    v_cvt_pk_bf16_f32 v227, v114, v115
    v_pk_fma_f32 v[116:117], v[116:117], s[62:63], v[240:241] op_sel:[0,1,0] op_sel_hi:[1,1,0] neg_lo:[0,0,1] neg_hi:[0,0,1]
    s_waitcnt lgkmcnt(8)
    s_add_u32 m0, s81, 4096
    s_add_u32 s77, s77, 14336
    v_pk_fma_f32 v[118:119], v[118:119], s[62:63], v[240:241] op_sel:[0,1,0] op_sel_hi:[1,1,0] neg_lo:[0,0,1] neg_hi:[0,0,1]
    buffer_load_dwordx4 v247, s[28:31], s77 offen offset:0 lds
    v_pk_fma_f32 v[120:121], v[120:121], s[62:63], v[240:241] op_sel:[0,1,0] op_sel_hi:[1,1,0] neg_lo:[0,0,1] neg_hi:[0,0,1]
    v_pk_fma_f32 v[122:123], v[122:123], s[62:63], v[240:241] op_sel:[0,1,0] op_sel_hi:[1,1,0] neg_lo:[0,0,1] neg_hi:[0,0,1]
    v_pk_fma_f32 v[124:125], v[124:125], s[62:63], v[240:241] op_sel:[0,1,0] op_sel_hi:[1,1,0] neg_lo:[0,0,1] neg_hi:[0,0,1]
    v_pk_fma_f32 v[126:127], v[126:127], s[62:63], v[240:241] op_sel:[0,1,0] op_sel_hi:[1,1,0] neg_lo:[0,0,1] neg_hi:[0,0,1]
    v_pk_fma_f32 v[128:129], v[128:129], s[62:63], v[240:241] op_sel:[0,1,0] op_sel_hi:[1,1,0] neg_lo:[0,0,1] neg_hi:[0,0,1]
    v_pk_fma_f32 v[130:131], v[130:131], s[62:63], v[240:241] op_sel:[0,1,0] op_sel_hi:[1,1,0] neg_lo:[0,0,1] neg_hi:[0,0,1]
    v_exp_f32_e32 v116, v116
    v_exp_f32_e64 v117, v117
    v_mfma_f32_32x32x16_bf16 v[196:211], v[12:15], v[220:223], v[196:211]
    buffer_load_dwordx4 v248, s[28:31], s77 offen offset:1024 lds
    v_exp_f32_e64 v118, v118
    ds_read_b64_tr_b16 a[96:97], v251 offset:8192
    v_exp_f32_e64 v119, v119
    ds_read_b64_tr_b16 a[98:99], v251 offset:8704
    v_exp_f32_e64 v120, v120
    ds_read_b64_tr_b16 a[100:101], v252 offset:8192
    v_exp_f32_e64 v121, v121
    ds_read_b64_tr_b16 a[102:103], v252 offset:8704
    v_exp_f32_e64 v122, v122
    v_mfma_f32_32x32x16_bf16 v[196:211], v[16:19], v[224:227], v[196:211]
    s_waitcnt lgkmcnt(4)
    s_add_u32 m0, s81, 6144
    s_add_u32 s77, s77, 14336
    v_exp_f32_e32 v123, v123
    buffer_load_dwordx4 v247, s[28:31], s77 offen offset:0 lds
    v_exp_f32_e64 v124, v124
    v_exp_f32_e64 v125, v125
    ds_read_b64_tr_b16 v[12:13], v237 offset:8192
    v_exp_f32_e64 v126, v126
    ds_read_b64_tr_b16 v[14:15], v238 offset:8192
    v_exp_f32_e64 v127, v127
    ds_read_b64_tr_b16 v[16:17], v237 offset:8448
    buffer_load_dwordx4 v248, s[28:31], s77 offen offset:1024 lds
    v_exp_f32_e64 v128, v128
    ds_read_b64_tr_b16 a[104:105], v251 offset:10240
    ds_read_b64_tr_b16 v[18:19], v238 offset:8448
    ds_read_b64_tr_b16 a[106:107], v251 offset:10752
    v_exp_f32_e64 v129, v129
    ds_read_b64_tr_b16 a[108:109], v252 offset:10240
    v_exp_f32_e64 v130, v130
    ds_read_b64_tr_b16 a[110:111], v252 offset:10752
    v_exp_f32_e64 v131, v131
    v_cvt_pk_bf16_f32 v228, v116, v117
    v_cvt_pk_bf16_f32 v229, v118, v119
    v_cvt_pk_bf16_f32 v230, v120, v121
    s_waitcnt lgkmcnt(8)
    s_add_u32 m0, s81, 8192
    s_add_u32 s77, s77, 14336
    v_cvt_pk_bf16_f32 v231, v122, v123
    buffer_load_dwordx4 v247, s[28:31], s77 offen offset:0 lds
    v_cvt_pk_bf16_f32 v232, v124, v125
    v_cvt_pk_bf16_f32 v233, v126, v127
    v_cvt_pk_bf16_f32 v234, v128, v129
    v_cvt_pk_bf16_f32 v235, v130, v131
    v_pk_fma_f32 v[132:133], v[132:133], s[62:63], v[240:241] op_sel:[0,1,0] op_sel_hi:[1,1,0] neg_lo:[0,0,1] neg_hi:[0,0,1]
    v_pk_fma_f32 v[134:135], v[134:135], s[62:63], v[240:241] op_sel:[0,1,0] op_sel_hi:[1,1,0] neg_lo:[0,0,1] neg_hi:[0,0,1]
    v_pk_fma_f32 v[136:137], v[136:137], s[62:63], v[240:241] op_sel:[0,1,0] op_sel_hi:[1,1,0] neg_lo:[0,0,1] neg_hi:[0,0,1]
    v_pk_fma_f32 v[138:139], v[138:139], s[62:63], v[240:241] op_sel:[0,1,0] op_sel_hi:[1,1,0] neg_lo:[0,0,1] neg_hi:[0,0,1]
    v_pk_fma_f32 v[140:141], v[140:141], s[62:63], v[240:241] op_sel:[0,1,0] op_sel_hi:[1,1,0] neg_lo:[0,0,1] neg_hi:[0,0,1]
    v_pk_fma_f32 v[142:143], v[142:143], s[62:63], v[240:241] op_sel:[0,1,0] op_sel_hi:[1,1,0] neg_lo:[0,0,1] neg_hi:[0,0,1]
    v_pk_fma_f32 v[144:145], v[144:145], s[62:63], v[240:241] op_sel:[0,1,0] op_sel_hi:[1,1,0] neg_lo:[0,0,1] neg_hi:[0,0,1]
    v_pk_fma_f32 v[146:147], v[146:147], s[62:63], v[240:241] op_sel:[0,1,0] op_sel_hi:[1,1,0] neg_lo:[0,0,1] neg_hi:[0,0,1]
    buffer_load_dwordx4 v248, s[28:31], s77 offen offset:1024 lds
    v_exp_f32_e32 v132, v132
    ds_read_b64_tr_b16 a[112:113], v251 offset:12288
    v_exp_f32_e64 v133, v133
    ds_read_b64_tr_b16 a[114:115], v251 offset:12800
    v_mfma_f32_32x32x16_bf16 v[196:211], v[20:23], v[228:231], v[196:211]
    ds_read_b64_tr_b16 a[116:117], v252 offset:12288
    v_exp_f32_e64 v134, v134
    ds_read_b64_tr_b16 a[118:119], v252 offset:12800
    v_exp_f32_e64 v135, v135
    v_exp_f32_e64 v136, v136
    s_waitcnt lgkmcnt(4)
    s_add_u32 m0, s81, 10240
    s_add_u32 s77, s77, 14336
    v_exp_f32_e32 v137, v137
    buffer_load_dwordx4 v247, s[28:31], s77 offen offset:0 lds
    v_exp_f32_e64 v138, v138
    v_mfma_f32_32x32x16_bf16 v[196:211], v[24:27], v[232:235], v[196:211]
    v_exp_f32_e64 v139, v139
    v_exp_f32_e64 v140, v140
    v_exp_f32_e64 v141, v141
    ds_read_b64_tr_b16 v[20:21], v237 offset:6144
    buffer_load_dwordx4 v248, s[28:31], s77 offen offset:1024 lds
    v_exp_f32_e64 v142, v142
    ds_read_b64_tr_b16 a[120:121], v251 offset:14336
    ds_read_b64_tr_b16 v[22:23], v238 offset:6144
    ds_read_b64_tr_b16 a[122:123], v251 offset:14848
    v_exp_f32_e64 v143, v143
    ds_read_b64_tr_b16 a[124:125], v252 offset:14336
    ds_read_b64_tr_b16 v[24:25], v237 offset:6400
    ds_read_b64_tr_b16 a[126:127], v252 offset:14848
    v_exp_f32_e64 v144, v144
    ds_read_b64_tr_b16 v[26:27], v238 offset:6400
    v_exp_f32_e64 v145, v145
    v_exp_f32_e64 v146, v146
    s_waitcnt lgkmcnt(8)
    s_add_u32 m0, s81, 12288
    v_exp_f32_e32 v147, v147
    buffer_load_dwordx4 v247, s[32:35], s79 offen offset:0 lds
    v_cvt_pk_bf16_f32 v220, v132, v133
    v_cvt_pk_bf16_f32 v221, v134, v135
    v_cvt_pk_bf16_f32 v222, v136, v137
    v_cvt_pk_bf16_f32 v223, v138, v139
    v_cvt_pk_bf16_f32 v224, v140, v141
    v_cvt_pk_bf16_f32 v225, v142, v143
    v_cvt_pk_bf16_f32 v226, v144, v145
    v_cvt_pk_bf16_f32 v227, v146, v147
    s_mov_b64 exec, s[64:65]
    buffer_load_dword v48, v246, s[24:27], 0 offen sc1
    s_mov_b64 exec, -1
    v_pk_fma_f32 v[148:149], v[148:149], s[62:63], v[240:241] op_sel:[0,1,0] op_sel_hi:[1,1,0] neg_lo:[0,0,1] neg_hi:[0,0,1]
    v_pk_fma_f32 v[150:151], v[150:151], s[62:63], v[240:241] op_sel:[0,1,0] op_sel_hi:[1,1,0] neg_lo:[0,0,1] neg_hi:[0,0,1]
    v_pk_fma_f32 v[152:153], v[152:153], s[62:63], v[240:241] op_sel:[0,1,0] op_sel_hi:[1,1,0] neg_lo:[0,0,1] neg_hi:[0,0,1]
    buffer_load_dwordx4 v248, s[32:35], s79 offen offset:1024 lds
    v_pk_fma_f32 v[154:155], v[154:155], s[62:63], v[240:241] op_sel:[0,1,0] op_sel_hi:[1,1,0] neg_lo:[0,0,1] neg_hi:[0,0,1]
    s_waitcnt vmcnt(25)
    ds_read_b64_tr_b16 a[128:129], v249 offset:0
    v_pk_fma_f32 v[156:157], v[156:157], s[62:63], v[240:241] op_sel:[0,1,0] op_sel_hi:[1,1,0] neg_lo:[0,0,1] neg_hi:[0,0,1]
    ds_read_b64_tr_b16 a[130:131], v249 offset:512
    v_pk_fma_f32 v[158:159], v[158:159], s[62:63], v[240:241] op_sel:[0,1,0] op_sel_hi:[1,1,0] neg_lo:[0,0,1] neg_hi:[0,0,1]
    ds_read_b64_tr_b16 a[132:133], v250 offset:0
    v_pk_fma_f32 v[160:161], v[160:161], s[62:63], v[240:241] op_sel:[0,1,0] op_sel_hi:[1,1,0] neg_lo:[0,0,1] neg_hi:[0,0,1]
    ds_read_b64_tr_b16 a[134:135], v250 offset:512
    v_pk_fma_f32 v[162:163], v[162:163], s[62:63], v[240:241] op_sel:[0,1,0] op_sel_hi:[1,1,0] neg_lo:[0,0,1] neg_hi:[0,0,1]
    v_exp_f32_e32 v148, v148
    v_exp_f32_e64 v149, v149
    v_mfma_f32_32x32x16_bf16 v[196:211], v[12:15], v[220:223], v[196:211]
    s_waitcnt lgkmcnt(5)
    s_add_u32 m0, s81, 14336
    s_add_u32 s79, s79, 14336
    v_exp_f32_e32 v150, v150
    buffer_load_dwordx4 v247, s[32:35], s79 offen offset:0 lds
    v_exp_f32_e64 v151, v151
    v_exp_f32_e64 v152, v152
    v_exp_f32_e64 v153, v153
    v_exp_f32_e64 v154, v154
    v_mfma_f32_32x32x16_bf16 v[196:211], v[16:19], v[224:227], v[196:211]
    v_exp_f32_e64 v155, v155
    buffer_load_dwordx4 v248, s[32:35], s79 offen offset:1024 lds
    v_exp_f32_e64 v156, v156
    v_exp_f32_e64 v157, v157
    ds_read_b64_tr_b16 v[12:13], v237 offset:4096
    v_exp_f32_e64 v158, v158
    ds_read_b64_tr_b16 v[14:15], v238 offset:4096
    v_exp_f32_e64 v159, v159
    ds_read_b64_tr_b16 v[16:17], v237 offset:4352
    v_exp_f32_e64 v160, v160
    ds_read_b64_tr_b16 v[18:19], v238 offset:4352
    v_exp_f32_e64 v161, v161
    s_waitcnt lgkmcnt(4)
    s_add_u32 m0, s80, 0
    s_add_u32 s79, s79, 7168
    v_exp_f32_e64 v162, v162
    buffer_load_dwordx4 v247, s[32:35], s79 offen offset:0 lds
    v_exp_f32_e64 v163, v163
    v_cvt_pk_bf16_f32 v228, v148, v149
    v_cvt_pk_bf16_f32 v229, v150, v151
    v_cvt_pk_bf16_f32 v230, v152, v153
    v_cvt_pk_bf16_f32 v231, v154, v155
    v_cvt_pk_bf16_f32 v232, v156, v157
    v_cvt_pk_bf16_f32 v233, v158, v159
    v_cvt_pk_bf16_f32 v234, v160, v161
    v_cvt_pk_bf16_f32 v235, v162, v163
    buffer_load_dwordx4 v248, s[32:35], s79 offen offset:1024 lds
    s_waitcnt vmcnt(5)
    v_cmp_ne_u32 vcc, s57, v48
    s_nop 1
    s_and_b64 vcc, vcc, s[64:65]
    s_cbranch_scc0 L_pok18
    s_mov_b32 s84, 0
L_psp18:
    s_sleep 2
    s_mov_b64 exec, s[64:65]
    buffer_load_dword v48, v246, s[24:27], 0 offen sc1
    s_mov_b64 exec, -1
    s_add_u32 s84, s84, 1
    s_cmp_gt_u32 s84, 1048576
    s_cbranch_scc1 L_exit
    s_waitcnt vmcnt(0)
    v_cmp_ne_u32 vcc, s57, v48
    s_nop 1
    s_and_b64 vcc, vcc, s[64:65]
    s_cbranch_scc1 L_psp18
L_pok18:
    v_and_b32_e64 v33, 31, v0
    v_lshlrev_b32_e64 v33, 2, v33
    buffer_load_dword v28, v33, s[24:27], s74 offen sc1
    buffer_load_dword v244, v33, s[24:27], s83 offen sc1
    s_xor_b32 s83, s83, 0x80
    buffer_load_dword v245, v33, s[24:27], s83 offen sc1
    v_pk_fma_f32 v[164:165], v[164:165], s[62:63], v[240:241] op_sel:[0,1,0] op_sel_hi:[1,1,0] neg_lo:[0,0,1] neg_hi:[0,0,1]
    v_pk_fma_f32 v[166:167], v[166:167], s[62:63], v[240:241] op_sel:[0,1,0] op_sel_hi:[1,1,0] neg_lo:[0,0,1] neg_hi:[0,0,1]
    buffer_load_dwordx4 v[84:87], v1, s[8:11], s78 offen offset:0 sc1
    v_pk_fma_f32 v[168:169], v[168:169], s[62:63], v[240:241] op_sel:[0,1,0] op_sel_hi:[1,1,0] neg_lo:[0,0,1] neg_hi:[0,0,1]
    v_pk_fma_f32 v[170:171], v[170:171], s[62:63], v[240:241] op_sel:[0,1,0] op_sel_hi:[1,1,0] neg_lo:[0,0,1] neg_hi:[0,0,1]
    v_pk_fma_f32 v[172:173], v[172:173], s[62:63], v[240:241] op_sel:[0,1,0] op_sel_hi:[1,1,0] neg_lo:[0,0,1] neg_hi:[0,0,1]
    v_pk_fma_f32 v[174:175], v[174:175], s[62:63], v[240:241] op_sel:[0,1,0] op_sel_hi:[1,1,0] neg_lo:[0,0,1] neg_hi:[0,0,1]
    v_pk_fma_f32 v[176:177], v[176:177], s[62:63], v[240:241] op_sel:[0,1,0] op_sel_hi:[1,1,0] neg_lo:[0,0,1] neg_hi:[0,0,1]
    v_pk_fma_f32 v[178:179], v[178:179], s[62:63], v[240:241] op_sel:[0,1,0] op_sel_hi:[1,1,0] neg_lo:[0,0,1] neg_hi:[0,0,1]
    v_exp_f32_e64 v164, v164
    v_exp_f32_e64 v165, v165
    v_mfma_f32_32x32x16_bf16 v[196:211], v[20:23], v[228:231], v[196:211]
    v_exp_f32_e64 v166, v166
    v_exp_f32_e64 v167, v167
    buffer_load_dwordx4 v[88:91], v254, s[8:11], s78 offen offset:0 sc1
    v_exp_f32_e64 v168, v168
    v_exp_f32_e64 v169, v169
    v_exp_f32_e64 v170, v170
    v_mfma_f32_32x32x16_bf16 v[196:211], v[24:27], v[232:235], v[196:211]
    v_exp_f32_e64 v171, v171
    v_exp_f32_e64 v172, v172
    v_exp_f32_e64 v173, v173
    ds_read_b64_tr_b16 v[20:21], v237 offset:2048
    v_exp_f32_e64 v174, v174
    buffer_load_dwordx4 v[92:95], v1, s[8:11], s78 offen offset:1024 sc1
    ds_read_b64_tr_b16 v[22:23], v238 offset:2048
    v_exp_f32_e64 v175, v175
    ds_read_b64_tr_b16 v[24:25], v237 offset:2304
    v_exp_f32_e64 v176, v176
    ds_read_b64_tr_b16 v[26:27], v238 offset:2304
    v_exp_f32_e64 v177, v177
    v_exp_f32_e64 v178, v178
    v_exp_f32_e64 v179, v179
    v_cvt_pk_bf16_f32 v220, v164, v165
    v_cvt_pk_bf16_f32 v221, v166, v167
    buffer_load_dwordx4 v[96:99], v254, s[8:11], s78 offen offset:1024 sc1
    v_cvt_pk_bf16_f32 v222, v168, v169
    v_cvt_pk_bf16_f32 v223, v170, v171
    v_cvt_pk_bf16_f32 v224, v172, v173
    v_cvt_pk_bf16_f32 v225, v174, v175
    v_cvt_pk_bf16_f32 v226, v176, v177
    v_cvt_pk_bf16_f32 v227, v178, v179
    v_pk_fma_f32 v[180:181], v[180:181], s[62:63], v[240:241] op_sel:[0,1,0] op_sel_hi:[1,1,0] neg_lo:[0,0,1] neg_hi:[0,0,1]
    v_pk_fma_f32 v[182:183], v[182:183], s[62:63], v[240:241] op_sel:[0,1,0] op_sel_hi:[1,1,0] neg_lo:[0,0,1] neg_hi:[0,0,1]
    v_pk_fma_f32 v[184:185], v[184:185], s[62:63], v[240:241] op_sel:[0,1,0] op_sel_hi:[1,1,0] neg_lo:[0,0,1] neg_hi:[0,0,1]
    v_pk_fma_f32 v[186:187], v[186:187], s[62:63], v[240:241] op_sel:[0,1,0] op_sel_hi:[1,1,0] neg_lo:[0,0,1] neg_hi:[0,0,1]
    v_pk_fma_f32 v[188:189], v[188:189], s[62:63], v[240:241] op_sel:[0,1,0] op_sel_hi:[1,1,0] neg_lo:[0,0,1] neg_hi:[0,0,1]
    v_pk_fma_f32 v[190:191], v[190:191], s[62:63], v[240:241] op_sel:[0,1,0] op_sel_hi:[1,1,0] neg_lo:[0,0,1] neg_hi:[0,0,1]
    v_pk_fma_f32 v[192:193], v[192:193], s[62:63], v[240:241] op_sel:[0,1,0] op_sel_hi:[1,1,0] neg_lo:[0,0,1] neg_hi:[0,0,1]
    v_pk_fma_f32 v[194:195], v[194:195], s[62:63], v[240:241] op_sel:[0,1,0] op_sel_hi:[1,1,0] neg_lo:[0,0,1] neg_hi:[0,0,1]
    v_exp_f32_e64 v180, v180
    buffer_load_dwordx4 v[100:103], v1, s[8:11], s78 offen offset:2048 sc1
    v_exp_f32_e64 v181, v181
    s_waitcnt lgkmcnt(6)
    v_mfma_f32_32x32x16_bf16 v[196:211], v[12:15], v[220:223], v[196:211]
    v_exp_f32_e32 v182, v182
    v_exp_f32_e64 v183, v183
    v_exp_f32_e64 v184, v184
    v_exp_f32_e64 v185, v185
    v_exp_f32_e64 v186, v186
    s_waitcnt lgkmcnt(4)
    v_mfma_f32_32x32x16_bf16 v[196:211], v[16:19], v[224:227], v[196:211]
    buffer_load_dwordx4 v[104:107], v254, s[8:11], s78 offen offset:2048 sc1
    v_exp_f32_e32 v187, v187
    v_exp_f32_e64 v188, v188
    v_exp_f32_e64 v189, v189
    ds_read_b64_tr_b16 v[12:13], v237 offset:0
    v_exp_f32_e64 v190, v190
    ds_read_b64_tr_b16 v[14:15], v238 offset:0
    v_exp_f32_e64 v191, v191
    ds_read_b64_tr_b16 v[16:17], v237 offset:256
    v_exp_f32_e64 v192, v192
    buffer_load_dwordx4 v[108:111], v1, s[8:11], s78 offen offset:3072 sc1
    ds_read_b64_tr_b16 v[18:19], v238 offset:256
    v_exp_f32_e64 v193, v193
    v_exp_f32_e64 v194, v194
    v_exp_f32_e64 v195, v195
    v_cvt_pk_bf16_f32 v228, v180, v181
    v_cvt_pk_bf16_f32 v229, v182, v183
    v_cvt_pk_bf16_f32 v230, v184, v185
    v_cvt_pk_bf16_f32 v231, v186, v187
    v_cvt_pk_bf16_f32 v232, v188, v189
    v_cvt_pk_bf16_f32 v233, v190, v191
    v_cvt_pk_bf16_f32 v234, v192, v193
    v_cvt_pk_bf16_f32 v235, v194, v195
    buffer_load_dwordx4 v[112:115], v254, s[8:11], s78 offen offset:3072 sc1
    v_pk_fma_f32 v[68:69], v[68:69], s[62:63], v[240:241] op_sel:[0,1,0] op_sel_hi:[1,1,0] neg_lo:[0,0,1] neg_hi:[0,0,1]
    v_pk_fma_f32 v[70:71], v[70:71], s[62:63], v[240:241] op_sel:[0,1,0] op_sel_hi:[1,1,0] neg_lo:[0,0,1] neg_hi:[0,0,1]
    v_pk_fma_f32 v[72:73], v[72:73], s[62:63], v[240:241] op_sel:[0,1,0] op_sel_hi:[1,1,0] neg_lo:[0,0,1] neg_hi:[0,0,1]
    v_pk_fma_f32 v[74:75], v[74:75], s[62:63], v[240:241] op_sel:[0,1,0] op_sel_hi:[1,1,0] neg_lo:[0,0,1] neg_hi:[0,0,1]
    v_pk_fma_f32 v[76:77], v[76:77], s[62:63], v[240:241] op_sel:[0,1,0] op_sel_hi:[1,1,0] neg_lo:[0,0,1] neg_hi:[0,0,1]
    v_pk_fma_f32 v[78:79], v[78:79], s[62:63], v[240:241] op_sel:[0,1,0] op_sel_hi:[1,1,0] neg_lo:[0,0,1] neg_hi:[0,0,1]
    v_pk_fma_f32 v[80:81], v[80:81], s[62:63], v[240:241] op_sel:[0,1,0] op_sel_hi:[1,1,0] neg_lo:[0,0,1] neg_hi:[0,0,1]
    v_pk_fma_f32 v[82:83], v[82:83], s[62:63], v[240:241] op_sel:[0,1,0] op_sel_hi:[1,1,0] neg_lo:[0,0,1] neg_hi:[0,0,1]
    v_exp_f32_e64 v68, v68
    v_exp_f32_e64 v69, v69
    s_waitcnt lgkmcnt(6)
    v_mfma_f32_32x32x16_bf16 v[196:211], v[20:23], v[228:231], v[196:211]
    v_exp_f32_e32 v70, v70
    s_add_u32 s78, s78, 0x1000
    buffer_load_dwordx4 v[116:119], v1, s[8:11], s78 offen offset:0 sc1
    v_exp_f32_e64 v71, v71
    v_exp_f32_e64 v72, v72
    v_exp_f32_e64 v73, v73
    v_exp_f32_e64 v74, v74
    s_waitcnt lgkmcnt(4)
    v_mfma_f32_32x32x16_bf16 v[196:211], v[24:27], v[232:235], v[196:211]
    v_exp_f32_e32 v75, v75
    v_exp_f32_e64 v76, v76
    buffer_load_dwordx4 v[120:123], v254, s[8:11], s78 offen offset:0 sc1
    v_exp_f32_e64 v77, v77
    v_exp_f32_e64 v78, v78
    v_exp_f32_e64 v79, v79
    v_exp_f32_e64 v80, v80
    v_exp_f32_e64 v81, v81
    v_exp_f32_e64 v82, v82
    v_exp_f32_e64 v83, v83
    v_cvt_pk_bf16_f32 v220, v68, v69
    buffer_load_dwordx4 v[124:127], v1, s[8:11], s78 offen offset:1024 sc1
    v_cvt_pk_bf16_f32 v221, v70, v71
    v_cvt_pk_bf16_f32 v222, v72, v73
    v_cvt_pk_bf16_f32 v223, v74, v75
    v_cvt_pk_bf16_f32 v224, v76, v77
    v_cvt_pk_bf16_f32 v225, v78, v79
    v_cvt_pk_bf16_f32 v226, v80, v81
    v_cvt_pk_bf16_f32 v227, v82, v83
    s_waitcnt lgkmcnt(2)
    v_mfma_f32_32x32x16_bf16 v[196:211], v[12:15], v[220:223], v[196:211]
    s_waitcnt lgkmcnt(0)
    v_mfma_f32_32x32x16_bf16 v[196:211], v[16:19], v[224:227], v[196:211]
    buffer_load_dwordx4 v[128:131], v254, s[8:11], s78 offen offset:1024 sc1
    s_cmp_lg_u32 s76, 0
    s_cbranch_scc0 L_nofinal
    s_mov_b32 s64, 0xffff
    s_movk_i32 s85, 0x80
    s_waitcnt vmcnt(11)
    v_mfma_f32_32x32x16_bf16 v[52:67], a[0:3], v[84:87], 0
    buffer_load_dwordx4 v[132:135], v1, s[8:11], s78 offen offset:2048 sc1
    v_mfma_f32_32x32x16_bf16 v[212:227], a[4:7], v[84:87], 0
    v_mul_f32_e64 v35, s62, v28
    v_exp_f32_e64 v35, v35
    s_nop 0
    v_cndmask_b32 v36, v208, v196, s[68:69]
    s_waitcnt vmcnt(11)
    v_mfma_f32_32x32x16_bf16 v[228:243], a[4:7], v[88:91], 0
    v_mov_b32_e64 v37, v36
    v_add_f32_e64 v35, 1.0, v35
    v_mul_f32_e64 v244, s62, v244
    v_permlane32_swap_b32 v36, v37
    v_mul_f32_e32 v245, s62, v245
    v_cndmask_b32 v36, v37, v36, s[68:69]
    v_mfma_f32_32x32x16_bf16 v[68:83], a[0:3], v[88:91], 0
    v_mul_f32_e64 v35, v35, v36
    v_rcp_f32_e64 v35, v35
    v_exp_f32 v244, -v244
    s_waitcnt vmcnt(10)
    v_mfma_f32_32x32x16_bf16 v[52:67], a[8:11], v[92:95], v[52:67]
    v_and_b32_e32 v36, v30, v35
    v_and_b32_e64 v37, v32, v35
    v_mul_f32_e64 v196, v196, v36
    v_mul_f32_e64 v197, v197, v35
    v_mul_f32_e64 v198, v198, v35
    v_mul_f32_e64 v199, v199, v35
    v_mfma_f32_32x32x16_bf16 v[212:227], a[12:15], v[92:95], v[212:227]
    v_mul_f32_e64 v200, v200, v35
    v_mul_f32_e64 v201, v201, v35
    v_mul_f32_e64 v202, v202, v35
    v_mul_f32_e64 v203, v203, v35
    v_cvt_pk_bf16_f32 v196, v196, v197
    s_waitcnt vmcnt(9)
    v_mfma_f32_32x32x16_bf16 v[228:243], a[12:15], v[96:99], v[228:243]
    v_cvt_pk_bf16_f32 v197, v198, v199
    v_cvt_pk_bf16_f32 v198, v200, v201
    v_cvt_pk_bf16_f32 v199, v202, v203
    buffer_store_dwordx4 v[196:199], v1, s[24:27], s75 offen offset:0 sc1
    v_mfma_f32_32x32x16_bf16 v[68:83], a[8:11], v[96:99], v[68:83]
    v_mul_f32_e32 v204, v204, v35
    v_mul_f32_e64 v205, v205, v35
    v_mul_f32_e64 v206, v206, v35
    v_mul_f32_e64 v207, v207, v35
    v_mul_f32_e64 v208, v208, v37
    s_waitcnt vmcnt(9)
    v_mfma_f32_32x32x16_bf16 v[52:67], a[16:19], v[100:103], v[52:67]
    v_mul_f32_e32 v209, v209, v35
    v_mul_f32_e64 v210, v210, v35
    v_mul_f32_e64 v211, v211, v35
    v_cvt_pk_bf16_f32 v204, v204, v205
    v_cvt_pk_bf16_f32 v205, v206, v207
    v_cvt_pk_bf16_f32 v206, v208, v209
    v_mfma_f32_32x32x16_bf16 v[212:227], a[20:23], v[100:103], v[212:227]
    v_cvt_pk_bf16_f32 v207, v210, v211
    buffer_store_dwordx4 v[204:207], v1, s[24:27], s75 offen offset:1024 sc1
    s_waitcnt vmcnt(9)
    v_mfma_f32_32x32x16_bf16 v[228:243], a[20:23], v[104:107], v[228:243]
    v_exp_f32 v245, -v245
    v_add_f32_e32 v244, 1.0, v244
    v_add_f32_e64 v245, 1.0, v245
    v_rcp_f32_e64 v244, v244
    v_mfma_f32_32x32x16_bf16 v[68:83], a[16:19], v[104:107], v[68:83]
    v_rcp_f32_e64 v245, v245
    buffer_load_dwordx4 v[136:139], v254, s[8:11], s78 offen offset:2048 sc1
    s_waitcnt vmcnt(9)
    v_mfma_f32_32x32x16_bf16 v[52:67], a[24:27], v[108:111], v[52:67]
    buffer_load_dwordx4 v[140:143], v1, s[8:11], s78 offen offset:3072 sc1
    v_mfma_f32_32x32x16_bf16 v[212:227], a[28:31], v[108:111], v[212:227]
    buffer_load_dwordx4 v[144:147], v254, s[8:11], s78 offen offset:3072 sc1
    s_waitcnt vmcnt(10)
    v_mfma_f32_32x32x16_bf16 v[228:243], a[28:31], v[112:115], v[228:243]
    s_add_u32 s78, s78, 0x1000
    buffer_load_dwordx4 v[148:151], v1, s[8:11], s78 offen offset:0 sc1
    v_mfma_f32_32x32x16_bf16 v[68:83], a[24:27], v[112:115], v[68:83]
    buffer_load_dwordx4 v[152:155], v254, s[8:11], s78 offen offset:0 sc1
    s_waitcnt vmcnt(11)
    v_mfma_f32_32x32x16_bf16 v[52:67], a[32:35], v[116:119], v[52:67]
    buffer_load_dwordx4 v[156:159], v1, s[8:11], s78 offen offset:1024 sc1
    v_mfma_f32_32x32x16_bf16 v[212:227], a[36:39], v[116:119], v[212:227]
    buffer_load_dwordx4 v[160:163], v254, s[8:11], s78 offen offset:1024 sc1
    s_waitcnt vmcnt(12)
    v_mfma_f32_32x32x16_bf16 v[228:243], a[36:39], v[120:123], v[228:243]
    buffer_load_dwordx4 v[164:167], v1, s[8:11], s78 offen offset:2048 sc1
    v_mfma_f32_32x32x16_bf16 v[68:83], a[32:35], v[120:123], v[68:83]
    buffer_load_dwordx4 v[168:171], v254, s[8:11], s78 offen offset:2048 sc1
    s_waitcnt vmcnt(13)
    v_mfma_f32_32x32x16_bf16 v[52:67], a[40:43], v[124:127], v[52:67]
    buffer_load_dwordx4 v[172:175], v1, s[8:11], s78 offen offset:3072 sc1
    v_mfma_f32_32x32x16_bf16 v[212:227], a[44:47], v[124:127], v[212:227]
    buffer_load_dwordx4 v[176:179], v254, s[8:11], s78 offen offset:3072 sc1
    s_waitcnt vmcnt(14)
    v_mfma_f32_32x32x16_bf16 v[228:243], a[44:47], v[128:131], v[228:243]
    s_add_u32 s78, s78, 0x1000
    buffer_load_dwordx4 v[180:183], v1, s[8:11], s78 offen offset:0 sc1
    v_mfma_f32_32x32x16_bf16 v[68:83], a[40:43], v[128:131], v[68:83]
    s_waitcnt vmcnt(14)
    v_mfma_f32_32x32x16_bf16 v[52:67], a[48:51], v[132:135], v[52:67]
    buffer_load_dwordx4 v[184:187], v254, s[8:11], s78 offen offset:0 sc1
    v_mfma_f32_32x32x16_bf16 v[212:227], a[52:55], v[132:135], v[212:227]
    s_waitcnt vmcnt(12)
    v_mfma_f32_32x32x16_bf16 v[228:243], a[52:55], v[136:139], v[228:243]
    ds_read_b64_tr_b16 a[136:137], v249 offset:2048
    ds_read_b64_tr_b16 a[138:139], v249 offset:2560
    ds_read_b64_tr_b16 a[140:141], v250 offset:2048
    ds_read_b64_tr_b16 a[142:143], v250 offset:2560
    ds_read_b64_tr_b16 a[144:145], v249 offset:4096
    ds_read_b64_tr_b16 a[146:147], v249 offset:4608
    v_mfma_f32_32x32x16_bf16 v[68:83], a[48:51], v[136:139], v[68:83]
    ds_read_b64_tr_b16 a[148:149], v250 offset:4096
    ds_read_b64_tr_b16 a[150:151], v250 offset:4608
    buffer_load_dwordx4 v[188:191], v1, s[8:11], s78 offen offset:1024 sc1
    s_waitcnt vmcnt(12)
    v_mfma_f32_32x32x16_bf16 v[52:67], a[56:59], v[140:143], v[52:67]
    buffer_load_dwordx4 v[192:195], v254, s[8:11], s78 offen offset:1024 sc1
    v_mfma_f32_32x32x16_bf16 v[212:227], a[60:63], v[140:143], v[212:227]
    buffer_load_dwordx4 v[196:199], v1, s[8:11], s78 offen offset:2048 sc1
    s_waitcnt vmcnt(13)
    v_mfma_f32_32x32x16_bf16 v[228:243], a[60:63], v[144:147], v[228:243]
    v_mfma_f32_32x32x16_bf16 v[68:83], a[56:59], v[144:147], v[68:83]
    buffer_load_dwordx4 v[200:203], v254, s[8:11], s78 offen offset:2048 sc1
    s_waitcnt vmcnt(13)
    v_mfma_f32_32x32x16_bf16 v[52:67], a[64:67], v[148:151], v[52:67]
    v_mfma_f32_32x32x16_bf16 v[212:227], a[68:71], v[148:151], v[212:227]
    buffer_load_dwordx4 v[204:207], v1, s[8:11], s78 offen offset:3072 sc1
    s_waitcnt vmcnt(13)
    v_mfma_f32_32x32x16_bf16 v[228:243], a[68:71], v[152:155], v[228:243]
    v_mfma_f32_32x32x16_bf16 v[68:83], a[64:67], v[152:155], v[68:83]
    buffer_load_dwordx4 v[208:211], v254, s[8:11], s78 offen offset:3072 sc1
    s_waitcnt vmcnt(13)
    v_mfma_f32_32x32x16_bf16 v[52:67], a[72:75], v[156:159], v[52:67]
    s_barrier
    s_cmp_eq_u32 s44, 0
    s_cbranch_scc0 L_nofl19
    v_mov_b32_e64 v33, s57
    s_mov_b32 exec_hi, 0
    buffer_store_dword v33, v50, s[24:27], 0 offen offset:256 sc1
    s_mov_b64 exec, -1
L_nofl19:
    v_mfma_f32_32x32x16_bf16 v[212:227], a[76:79], v[156:159], v[212:227]
    s_add_u32 s78, s78, 0x1000
    buffer_load_dwordx4 v[84:87], v1, s[8:11], s78 offen offset:0 sc1
    s_waitcnt vmcnt(13)
    v_mfma_f32_32x32x16_bf16 v[228:243], a[76:79], v[160:163], v[228:243]
    v_mfma_f32_32x32x16_bf16 v[68:83], a[72:75], v[160:163], v[68:83]
    buffer_load_dwordx4 v[88:91], v254, s[8:11], s78 offen offset:0 sc1
    s_waitcnt vmcnt(13)
    v_mfma_f32_32x32x16_bf16 v[52:67], a[80:83], v[164:167], v[52:67]
    buffer_load_dwordx4 v[92:95], v1, s[8:11], s78 offen offset:1024 sc1
    v_and_b32_e64 v18, 31, v0
    v_lshlrev_b32_e64 v18, 8, v18
    v_add_u32_e64 v18, s81, v18
    v_mfma_f32_32x32x16_bf16 v[212:227], a[84:87], v[164:167], v[212:227]
    v_lshrrev_b32_e64 v19, 5, v0
    v_lshlrev_b32_e64 v19, 1, v19
    v_and_b32_e64 v20, 7, v0
    v_xor_b32_e64 v19, v19, v20
    s_waitcnt vmcnt(13)
    v_mfma_f32_32x32x16_bf16 v[228:243], a[84:87], v[168:171], v[228:243]
    buffer_load_dwordx4 v[96:99], v254, s[8:11], s78 offen offset:1024 sc1
    v_mfma_f32_32x32x16_bf16 v[68:83], a[80:83], v[168:171], v[68:83]
    s_waitcnt vmcnt(13)
    v_mfma_f32_32x32x16_bf16 v[52:67], a[88:91], v[172:175], v[52:67]
    buffer_load_dwordx4 v[100:103], v1, s[8:11], s78 offen offset:2048 sc1
    v_mfma_f32_32x32x16_bf16 v[212:227], a[92:95], v[172:175], v[212:227]
    s_waitcnt vmcnt(13)
    v_mfma_f32_32x32x16_bf16 v[228:243], a[92:95], v[176:179], v[228:243]
    buffer_load_dwordx4 v[104:107], v254, s[8:11], s78 offen offset:2048 sc1
    v_mfma_f32_32x32x16_bf16 v[68:83], a[88:91], v[176:179], v[68:83]
    s_waitcnt vmcnt(13)
    v_mfma_f32_32x32x16_bf16 v[52:67], a[96:99], v[180:183], v[52:67]
    buffer_load_dwordx4 v[108:111], v1, s[8:11], s78 offen offset:3072 sc1
    v_lshl_add_u32 v4, v19, 4, v18
    v_xor_b32_e64 v5, 16, v4
    v_xor_b32_e64 v6, 64, v4
    v_xor_b32 v7, 0x50, v4
    v_mfma_f32_32x32x16_bf16 v[212:227], a[100:103], v[180:183], v[212:227]
    s_waitcnt vmcnt(13)
    v_mfma_f32_32x32x16_bf16 v[228:243], a[100:103], v[184:187], v[228:243]
    buffer_load_dwordx4 v[112:115], v254, s[8:11], s78 offen offset:3072 sc1
    v_mfma_f32_32x32x16_bf16 v[68:83], a[96:99], v[184:187], v[68:83]
    s_waitcnt vmcnt(13)
    v_mfma_f32_32x32x16_bf16 v[52:67], a[104:107], v[188:191], v[52:67]
    s_add_u32 s78, s78, 0x1000
    buffer_load_dwordx4 v[116:119], v1, s[8:11], s78 offen offset:0 sc1
    v_mfma_f32_32x32x16_bf16 v[212:227], a[108:111], v[188:191], v[212:227]
    buffer_load_dwordx4 v[120:123], v254, s[8:11], s78 offen offset:0 sc1
    s_waitcnt vmcnt(14)
    v_mfma_f32_32x32x16_bf16 v[228:243], a[108:111], v[192:195], v[228:243]
    v_mfma_f32_32x32x16_bf16 v[68:83], a[104:107], v[192:195], v[68:83]
    buffer_load_dwordx4 v[124:127], v1, s[8:11], s78 offen offset:1024 sc1
    s_waitcnt vmcnt(14)
    v_mfma_f32_32x32x16_bf16 v[52:67], a[112:115], v[196:199], v[52:67]
    v_mfma_f32_32x32x16_bf16 v[212:227], a[116:119], v[196:199], v[212:227]
    buffer_load_dwordx4 v[128:131], v254, s[8:11], s78 offen offset:1024 sc1
    s_waitcnt vmcnt(14)
    v_mfma_f32_32x32x16_bf16 v[228:243], a[116:119], v[200:203], v[228:243]
    v_lshrrev_b32_e32 v18, 3, v0
    v_and_b32_e64 v19, 3, v0
    v_lshlrev_b32_e64 v19, 1, v19
    v_xor_b32_e64 v19, v19, v18
    v_mfma_f32_32x32x16_bf16 v[68:83], a[112:115], v[200:203], v[68:83]
    buffer_load_dwordx4 v[132:135], v1, s[8:11], s78 offen offset:2048 sc1
    s_waitcnt vmcnt(14)
    v_mfma_f32_32x32x16_bf16 v[52:67], a[120:123], v[204:207], v[52:67]
    v_mfma_f32_32x32x16_bf16 v[212:227], a[124:127], v[204:207], v[212:227]
    buffer_load_dwordx4 v[136:139], v254, s[8:11], s78 offen offset:2048 sc1
    s_waitcnt vmcnt(14)
    v_mfma_f32_32x32x16_bf16 v[228:243], a[124:127], v[208:211], v[228:243]
    v_mfma_f32_32x32x16_bf16 v[68:83], a[120:123], v[208:211], v[68:83]
    buffer_load_dwordx4 v[140:143], v1, s[8:11], s78 offen offset:3072 sc1
    s_waitcnt vmcnt(14)
    v_mfma_f32_32x32x16_bf16 v[52:67], a[128:131], v[84:87], v[52:67]
    v_mfma_f32_32x32x16_bf16 v[212:227], a[132:135], v[84:87], v[212:227]
    buffer_load_dwordx4 v[144:147], v254, s[8:11], s78 offen offset:3072 sc1
    ds_read_b64_tr_b16 a[152:153], v249 offset:6144
    ds_read_b64_tr_b16 a[154:155], v249 offset:6656
    ds_read_b64_tr_b16 a[156:157], v250 offset:6144
    s_waitcnt vmcnt(14)
    v_mfma_f32_32x32x16_bf16 v[228:243], a[132:135], v[88:91], v[228:243]
    ds_read_b64_tr_b16 a[158:159], v250 offset:6656
    s_add_u32 s78, s78, 0x1000
    buffer_load_dwordx4 v[148:151], v1, s[8:11], s78 offen offset:0 sc1
    v_mfma_f32_32x32x16_bf16 v[68:83], a[128:131], v[88:91], v[68:83]
    v_lshlrev_b32_e64 v19, 4, v19
    v_lshl_add_u32 v19, v18, 8, v19
    v_bfe_u32 v20, v0, 2, 1
    v_lshl_add_u32 v19, v20, 7, v19
    s_waitcnt vmcnt(14) lgkmcnt(10)
    v_mfma_f32_32x32x16_bf16 v[52:67], a[136:139], v[92:95], v[52:67]
    buffer_load_dwordx4 v[152:155], v254, s[8:11], s78 offen offset:0 sc1
    ds_read_b64_tr_b16 a[160:161], v249 offset:8192
    ds_read_b64_tr_b16 a[162:163], v249 offset:8704
    ds_read_b64_tr_b16 a[164:165], v250 offset:8192
    s_waitcnt lgkmcnt(11)
    v_mfma_f32_32x32x16_bf16 v[212:227], a[140:143], v[92:95], v[212:227]
    s_mov_b64 exec, s[64:65]
    buffer_load_dword v48, v246, s[24:27], s85 offen sc1
    s_mov_b64 exec, -1
    ds_read_b64_tr_b16 a[166:167], v250 offset:8704
    s_waitcnt vmcnt(15)
    v_mfma_f32_32x32x16_bf16 v[228:243], a[140:143], v[96:99], v[228:243]
    buffer_load_dwordx4 v[156:159], v1, s[8:11], s78 offen offset:1024 sc1
    v_mfma_f32_32x32x16_bf16 v[68:83], a[136:139], v[96:99], v[68:83]
    s_waitcnt vmcnt(15) lgkmcnt(10)
    v_mfma_f32_32x32x16_bf16 v[52:67], a[144:147], v[100:103], v[52:67]
    buffer_load_dwordx4 v[160:163], v254, s[8:11], s78 offen offset:1024 sc1
    ds_read_b64_tr_b16 a[168:169], v249 offset:10240
    ds_read_b64_tr_b16 a[170:171], v249 offset:10752
    ds_read_b64_tr_b16 a[172:173], v250 offset:10240
    s_waitcnt lgkmcnt(11)
    v_mfma_f32_32x32x16_bf16 v[212:227], a[148:151], v[100:103], v[212:227]
    ds_read_b64_tr_b16 a[174:175], v250 offset:10752
    s_waitcnt vmcnt(15)
    v_mfma_f32_32x32x16_bf16 v[228:243], a[148:151], v[104:107], v[228:243]
    s_add_u32 m0, s80, 2048
    s_add_u32 s79, s79, 14336
    buffer_load_dwordx4 v247, s[32:35], s79 offen offset:0 lds
    v_mfma_f32_32x32x16_bf16 v[68:83], a[144:147], v[104:107], v[68:83]
    s_lshl_b32 s86, s44, 11
    s_add_u32 s86, s86, 98304
    v_add_u32_e32 v8, s86, v19
    v_xor_b32_e64 v9, 16, v8
    s_waitcnt vmcnt(15) lgkmcnt(10)
    v_mfma_f32_32x32x16_bf16 v[52:67], a[152:155], v[108:111], v[52:67]
    buffer_load_dwordx4 v248, s[32:35], s79 offen offset:1024 lds
    ds_read_b64_tr_b16 a[176:177], v251 offset:0
    ds_read_b64_tr_b16 a[178:179], v251 offset:512
    ds_read_b64_tr_b16 a[180:181], v252 offset:0
    s_waitcnt lgkmcnt(11)
    v_mfma_f32_32x32x16_bf16 v[212:227], a[156:159], v[108:111], v[212:227]
    ds_read_b64_tr_b16 a[182:183], v252 offset:512
    s_waitcnt vmcnt(15)
    v_mfma_f32_32x32x16_bf16 v[228:243], a[156:159], v[112:115], v[228:243]
    buffer_load_dwordx4 v[164:167], v1, s[8:11], s78 offen offset:2048 sc1
    v_mfma_f32_32x32x16_bf16 v[68:83], a[152:155], v[112:115], v[68:83]
    buffer_load_dwordx4 v[168:171], v254, s[8:11], s78 offen offset:2048 sc1
    s_waitcnt vmcnt(16) lgkmcnt(10)
    v_mfma_f32_32x32x16_bf16 v[52:67], a[160:163], v[116:119], v[52:67]
    ds_read_b64_tr_b16 a[184:185], v251 offset:2048
    ds_read_b64_tr_b16 a[186:187], v251 offset:2560
    ds_read_b64_tr_b16 a[188:189], v252 offset:2048
    ds_read_b64_tr_b16 a[190:191], v252 offset:2560
    s_waitcnt lgkmcnt(12)
    v_mfma_f32_32x32x16_bf16 v[212:227], a[164:167], v[116:119], v[212:227]
    s_add_u32 m0, s80, 4096
    s_add_u32 s79, s79, 14336
    buffer_load_dwordx4 v247, s[32:35], s79 offen offset:0 lds
    s_waitcnt vmcnt(16)
    v_mfma_f32_32x32x16_bf16 v[228:243], a[164:167], v[120:123], v[228:243]
    v_mfma_f32_32x32x16_bf16 v[68:83], a[160:163], v[120:123], v[68:83]
    buffer_load_dwordx4 v248, s[32:35], s79 offen offset:1024 lds
    s_waitcnt vmcnt(16) lgkmcnt(10)
    v_mfma_f32_32x32x16_bf16 v[52:67], a[168:171], v[124:127], v[52:67]
    s_waitcnt vmcnt(8)
    v_cmp_ne_u32 vcc, s57, v48
    s_nop 1
    s_and_b64 vcc, vcc, s[64:65]
    s_cbranch_scc0 L_pok20
    s_mov_b32 s84, 0
L_psp20:
    s_sleep 2
    s_mov_b64 exec, s[64:65]
    buffer_load_dword v48, v246, s[24:27], s85 offen sc1
    s_mov_b64 exec, -1
    s_add_u32 s84, s84, 1
    s_cmp_gt_u32 s84, 1048576
    s_cbranch_scc1 L_exit
    s_waitcnt vmcnt(0)
    v_cmp_ne_u32 vcc, s57, v48
    s_nop 1
    s_and_b64 vcc, vcc, s[64:65]
    s_cbranch_scc1 L_psp20
L_pok20:
    s_waitcnt lgkmcnt(8)
    v_mfma_f32_32x32x16_bf16 v[212:227], a[172:175], v[124:127], v[212:227]
    ds_read_b64_tr_b16 a[192:193], v251 offset:4096
    ds_read_b64_tr_b16 a[194:195], v251 offset:4608
    ds_read_b64_tr_b16 a[196:197], v252 offset:4096
    ds_read_b64_tr_b16 a[198:199], v252 offset:4608
    s_add_u32 m0, s80, 6144
    s_add_u32 s79, s79, 14336
    v_mfma_f32_32x32x16_bf16 v[228:243], a[172:175], v[128:131], v[228:243]
    buffer_load_dwordx4 v247, s[32:35], s79 offen offset:0 lds
    v_mul_u32_u24 v16, 0x380, v18
    v_and_b32_e64 v20, 7, v0
    v_lshl_add_u32 v16, v20, 4, v16
    v_add_u32 v17, 28672, v16
    v_mfma_f32_32x32x16_bf16 v[68:83], a[168:171], v[128:131], v[68:83]
    buffer_load_dwordx4 v248, s[32:35], s79 offen offset:1024 lds
    s_waitcnt lgkmcnt(10)
    v_mfma_f32_32x32x16_bf16 v[52:67], a[176:179], v[132:135], v[52:67]
    ds_read_b64_tr_b16 a[200:201], v251 offset:6144
    ds_read_b64_tr_b16 a[202:203], v251 offset:6656
    ds_read_b64_tr_b16 a[204:205], v252 offset:6144
    ds_read_b64_tr_b16 a[206:207], v252 offset:6656
    s_waitcnt lgkmcnt(12)
    v_mfma_f32_32x32x16_bf16 v[212:227], a[180:183], v[132:135], v[212:227]
    buffer_load_dwordx4 v[172:175], v1, s[8:11], s78 offen offset:3072 sc1
    v_mfma_f32_32x32x16_bf16 v[228:243], a[180:183], v[136:139], v[228:243]
    v_mfma_f32_32x32x16_bf16 v[68:83], a[176:179], v[136:139], v[68:83]
    buffer_load_dwordx4 v[176:179], v254, s[8:11], s78 offen offset:3072 sc1
    s_waitcnt lgkmcnt(10)
    v_mfma_f32_32x32x16_bf16 v[52:67], a[184:187], v[140:143], v[52:67]
    ds_read_b64_tr_b16 a[208:209], v251 offset:8192
    ds_read_b64_tr_b16 a[210:211], v251 offset:8704
    ds_read_b64_tr_b16 a[212:213], v252 offset:8192
    ds_read_b64_tr_b16 a[214:215], v252 offset:8704
    s_waitcnt lgkmcnt(12)
    v_mfma_f32_32x32x16_bf16 v[212:227], a[188:191], v[140:143], v[212:227]
    s_add_u32 m0, s80, 8192
    s_add_u32 s79, s79, 7168
    buffer_load_dwordx4 v247, s[32:35], s79 offen offset:0 lds
    v_mfma_f32_32x32x16_bf16 v[228:243], a[188:191], v[144:147], v[228:243]
    buffer_load_dwordx4 v248, s[32:35], s79 offen offset:1024 lds
    v_mfma_f32_32x32x16_bf16 v[68:83], a[184:187], v[144:147], v[68:83]
    s_waitcnt lgkmcnt(10)
    v_mfma_f32_32x32x16_bf16 v[52:67], a[192:195], v[148:151], v[52:67]
    s_add_u32 m0, s80, 10240
    s_add_u32 s79, s79, 14336
    buffer_load_dwordx4 v247, s[32:35], s79 offen offset:0 lds
    buffer_load_dwordx4 v248, s[32:35], s79 offen offset:1024 lds
    s_waitcnt lgkmcnt(8)
    v_mfma_f32_32x32x16_bf16 v[212:227], a[196:199], v[148:151], v[212:227]
    ds_read_b64_tr_b16 a[216:217], v251 offset:10240
    ds_read_b64_tr_b16 a[218:219], v251 offset:10752
    ds_read_b64_tr_b16 a[220:221], v252 offset:10240
    ds_read_b64_tr_b16 a[222:223], v252 offset:10752
    v_mfma_f32_32x32x16_bf16 v[228:243], a[196:199], v[152:155], v[228:243]
    v_mfma_f32_32x32x16_bf16 v[68:83], a[192:195], v[152:155], v[68:83]
    s_waitcnt vmcnt(15) lgkmcnt(10)
    v_mfma_f32_32x32x16_bf16 v[52:67], a[200:203], v[156:159], v[52:67]
    s_mov_b32 s78, s1
    buffer_load_dwordx4 v[180:183], v1, s[8:11], s78 offen offset:0 sc1
    buffer_load_dwordx4 v[184:187], v1, s[8:11], s78 offen offset:1024 sc1
    s_waitcnt lgkmcnt(8)
    v_mfma_f32_32x32x16_bf16 v[212:227], a[204:207], v[156:159], v[212:227]
    v_sub_u32_e32 v249, v249, v253
    v_sub_u32_e64 v250, v250, v253
    v_sub_u32_e64 v251, v251, v253
    v_sub_u32_e64 v252, v252, v253
    ds_read_b64_tr_b16 a[0:1], v251 offset:12288
    s_waitcnt vmcnt(16)
    v_mfma_f32_32x32x16_bf16 v[228:243], a[204:207], v[160:163], v[228:243]
    ds_read_b64_tr_b16 a[2:3], v251 offset:13312
    ds_read_b64_tr_b16 a[4:5], v252 offset:12288
    ds_read_b64_tr_b16 a[6:7], v252 offset:13312
    ds_read_b64_tr_b16 a[8:9], v251 offset:14336
    ds_read_b64_tr_b16 a[10:11], v251 offset:15360
    ds_read_b64_tr_b16 a[12:13], v252 offset:14336
    v_mfma_f32_32x32x16_bf16 v[68:83], a[200:203], v[160:163], v[68:83]
    ds_read_b64_tr_b16 a[14:15], v252 offset:15360
    s_waitcnt vmcnt(13) lgkmcnt(14)
    v_mfma_f32_32x32x16_bf16 v[52:67], a[208:211], v[164:167], v[52:67]
    buffer_load_dwordx4 v[188:191], v1, s[8:11], s78 offen offset:2048 sc1
    buffer_load_dwordx4 v[192:195], v1, s[8:11], s78 offen offset:3072 sc1
    s_waitcnt lgkmcnt(12)
    v_mfma_f32_32x32x16_bf16 v[212:227], a[212:215], v[164:167], v[212:227]
    ds_read_b64_tr_b16 a[16:17], v249 offset:0
    ds_read_b64_tr_b16 a[18:19], v249 offset:1024
    ds_read_b64_tr_b16 a[20:21], v250 offset:0
    ds_read_b64_tr_b16 a[22:23], v250 offset:1024
    ds_read_b64_tr_b16 a[24:25], v249 offset:2048
    s_waitcnt vmcnt(14)
    v_mfma_f32_32x32x16_bf16 v[228:243], a[212:215], v[168:171], v[228:243]
    ds_read_b64_tr_b16 a[26:27], v249 offset:3072
    ds_read_b64_tr_b16 a[28:29], v250 offset:2048
    ds_read_b64_tr_b16 a[30:31], v250 offset:3072
    v_mfma_f32_32x32x16_bf16 v[68:83], a[208:211], v[168:171], v[68:83]
    s_add_u32 s78, s78, 0x1000
    buffer_load_dwordx4 v[196:199], v1, s[8:11], s78 offen offset:0 sc1
    s_waitcnt vmcnt(10) lgkmcnt(15)
    v_mfma_f32_32x32x16_bf16 v[52:67], a[216:219], v[172:175], v[52:67]
    buffer_load_dwordx4 v[200:203], v1, s[8:11], s78 offen offset:1024 sc1
    v_mfma_f32_32x32x16_bf16 v[212:227], a[220:223], v[172:175], v[212:227]
    s_waitcnt vmcnt(10)
    v_mfma_f32_32x32x16_bf16 v[228:243], a[220:223], v[176:179], v[228:243]
    v_mfma_f32_32x32x16_bf16 v[68:83], a[216:219], v[176:179], v[68:83]
    buffer_load_dwordx4 v[204:207], v1, s[8:11], s78 offen offset:2048 sc1
    s_nop 5
    v_pk_mul_f32 v[52:53], v[52:53], v[244:245] op_sel:[0,0] op_sel_hi:[1,0]
    v_pk_mul_f32 v[54:55], v[54:55], v[244:245] op_sel:[0,0] op_sel_hi:[1,0]
    v_pk_mul_f32 v[56:57], v[56:57], v[244:245] op_sel:[0,0] op_sel_hi:[1,0]
    v_pk_mul_f32 v[58:59], v[58:59], v[244:245] op_sel:[0,0] op_sel_hi:[1,0]
    v_pk_mul_f32 v[60:61], v[60:61], v[244:245] op_sel:[0,0] op_sel_hi:[1,0]
    v_pk_mul_f32 v[62:63], v[62:63], v[244:245] op_sel:[0,0] op_sel_hi:[1,0]
    v_pk_mul_f32 v[64:65], v[64:65], v[244:245] op_sel:[0,0] op_sel_hi:[1,0]
    v_pk_mul_f32 v[66:67], v[66:67], v[244:245] op_sel:[0,0] op_sel_hi:[1,0]
    v_pk_mul_f32 v[212:213], v[212:213], v[244:245] op_sel:[0,0] op_sel_hi:[1,0]
    v_pk_mul_f32 v[214:215], v[214:215], v[244:245] op_sel:[0,0] op_sel_hi:[1,0]
    v_pk_mul_f32 v[216:217], v[216:217], v[244:245] op_sel:[0,0] op_sel_hi:[1,0]
    v_pk_mul_f32 v[218:219], v[218:219], v[244:245] op_sel:[0,0] op_sel_hi:[1,0]
    v_pk_mul_f32 v[220:221], v[220:221], v[244:245] op_sel:[0,0] op_sel_hi:[1,0]
    v_pk_mul_f32 v[222:223], v[222:223], v[244:245] op_sel:[0,0] op_sel_hi:[1,0]
    v_pk_mul_f32 v[224:225], v[224:225], v[244:245] op_sel:[0,0] op_sel_hi:[1,0]
    v_pk_mul_f32 v[226:227], v[226:227], v[244:245] op_sel:[0,0] op_sel_hi:[1,0]
    s_waitcnt vmcnt(6) lgkmcnt(14)
    v_mfma_f32_32x32x16_bf16 v[52:67], a[0:3], v[180:183], v[52:67]
    buffer_load_dwordx4 v[208:211], v1, s[8:11], s78 offen offset:3072 sc1
    ds_read_b64_tr_b16 a[32:33], v249 offset:4096
    ds_read_b64_tr_b16 a[34:35], v249 offset:5120
    ds_read_b64_tr_b16 a[36:37], v250 offset:4096
    s_waitcnt lgkmcnt(15)
    v_mfma_f32_32x32x16_bf16 v[212:227], a[4:7], v[180:183], v[212:227]
    ds_read_b64_tr_b16 a[38:39], v250 offset:5120
    v_pk_mul_f32 v[68:69], v[68:69], v[244:245] op_sel:[0,1] op_sel_hi:[1,1]
    v_pk_mul_f32 v[70:71], v[70:71], v[244:245] op_sel:[0,1] op_sel_hi:[1,1]
    v_pk_mul_f32 v[72:73], v[72:73], v[244:245] op_sel:[0,1] op_sel_hi:[1,1]
    v_pk_mul_f32 v[74:75], v[74:75], v[244:245] op_sel:[0,1] op_sel_hi:[1,1]
    s_waitcnt vmcnt(6) lgkmcnt(14)
    v_mfma_f32_32x32x16_bf16 v[52:67], a[8:11], v[184:187], v[52:67]
    v_pk_mul_f32 v[76:77], v[76:77], v[244:245] op_sel:[0,1] op_sel_hi:[1,1]
    v_pk_mul_f32 v[78:79], v[78:79], v[244:245] op_sel:[0,1] op_sel_hi:[1,1]
    v_pk_mul_f32 v[80:81], v[80:81], v[244:245] op_sel:[0,1] op_sel_hi:[1,1]
    v_pk_mul_f32 v[82:83], v[82:83], v[244:245] op_sel:[0,1] op_sel_hi:[1,1]
    v_pk_mul_f32 v[228:229], v[228:229], v[244:245] op_sel:[0,1] op_sel_hi:[1,1]
    s_waitcnt lgkmcnt(12)
    v_mfma_f32_32x32x16_bf16 v[212:227], a[12:15], v[184:187], v[212:227]
    s_mov_b32 s78, s1
    buffer_load_dwordx4 v[84:87], v254, s[8:11], s78 offen offset:0 sc1
    v_pk_mul_f32 v[230:231], v[230:231], v[244:245] op_sel:[0,1] op_sel_hi:[1,1]
    v_pk_mul_f32 v[232:233], v[232:233], v[244:245] op_sel:[0,1] op_sel_hi:[1,1]
    s_waitcnt vmcnt(6) lgkmcnt(10)
    v_mfma_f32_32x32x16_bf16 v[52:67], a[16:19], v[188:191], v[52:67]
    ds_read_b64_tr_b16 a[40:41], v249 offset:6144
    ds_read_b64_tr_b16 a[42:43], v249 offset:7168
    ds_read_b64_tr_b16 a[44:45], v250 offset:6144
    ds_read_b64_tr_b16 a[46:47], v250 offset:7168
    buffer_load_dwordx4 v[88:91], v254, s[8:11], s78 offen offset:1024 sc1
    s_waitcnt lgkmcnt(12)
    v_mfma_f32_32x32x16_bf16 v[212:227], a[20:23], v[188:191], v[212:227]
    v_pk_mul_f32 v[234:235], v[234:235], v[244:245] op_sel:[0,1] op_sel_hi:[1,1]
    v_pk_mul_f32 v[236:237], v[236:237], v[244:245] op_sel:[0,1] op_sel_hi:[1,1]
    v_pk_mul_f32 v[238:239], v[238:239], v[244:245] op_sel:[0,1] op_sel_hi:[1,1]
    v_pk_mul_f32 v[240:241], v[240:241], v[244:245] op_sel:[0,1] op_sel_hi:[1,1]
    v_pk_mul_f32 v[242:243], v[242:243], v[244:245] op_sel:[0,1] op_sel_hi:[1,1]
    s_waitcnt vmcnt(6) lgkmcnt(10)
    v_mfma_f32_32x32x16_bf16 v[52:67], a[24:27], v[192:195], v[52:67]
    buffer_load_dwordx4 v[92:95], v254, s[8:11], s78 offen offset:2048 sc1
    s_waitcnt lgkmcnt(8)
    v_mfma_f32_32x32x16_bf16 v[212:227], a[28:31], v[192:195], v[212:227]
    s_waitcnt vmcnt(6) lgkmcnt(6)
    v_mfma_f32_32x32x16_bf16 v[52:67], a[32:35], v[196:199], v[52:67]
    ds_read_b64_tr_b16 a[48:49], v249 offset:8192
    ds_read_b64_tr_b16 a[50:51], v249 offset:9216
    ds_read_b64_tr_b16 a[52:53], v250 offset:8192
    ds_read_b64_tr_b16 a[54:55], v250 offset:9216
    ds_read_b64_tr_b16 a[56:57], v249 offset:10240
    ds_read_b64_tr_b16 a[58:59], v249 offset:11264
    ds_read_b64_tr_b16 a[60:61], v250 offset:10240
    ds_read_b64_tr_b16 a[62:63], v250 offset:11264
    buffer_load_dwordx4 v[96:99], v254, s[8:11], s78 offen offset:3072 sc1
    s_waitcnt lgkmcnt(12)
    v_mfma_f32_32x32x16_bf16 v[212:227], a[36:39], v[196:199], v[212:227]
    s_waitcnt vmcnt(6) lgkmcnt(10)
    v_mfma_f32_32x32x16_bf16 v[52:67], a[40:43], v[200:203], v[52:67]
    s_add_u32 s78, s78, 0x1000
    buffer_load_dwordx4 v[100:103], v254, s[8:11], s78 offen offset:0 sc1
    s_waitcnt lgkmcnt(8)
    v_mfma_f32_32x32x16_bf16 v[212:227], a[44:47], v[200:203], v[212:227]
    s_waitcnt vmcnt(6) lgkmcnt(6)
    v_mfma_f32_32x32x16_bf16 v[52:67], a[48:51], v[204:207], v[52:67]
    buffer_load_dwordx4 v[104:107], v254, s[8:11], s78 offen offset:1024 sc1
    s_waitcnt lgkmcnt(4)
    v_mfma_f32_32x32x16_bf16 v[212:227], a[52:55], v[204:207], v[212:227]
    s_waitcnt vmcnt(6) lgkmcnt(2)
    v_mfma_f32_32x32x16_bf16 v[52:67], a[56:59], v[208:211], v[52:67]
    buffer_load_dwordx4 v[108:111], v254, s[8:11], s78 offen offset:2048 sc1
    s_waitcnt lgkmcnt(0)
    v_mfma_f32_32x32x16_bf16 v[212:227], a[60:63], v[208:211], v[212:227]
    s_waitcnt vmcnt(6)
    v_mfma_f32_32x32x16_bf16 v[68:83], a[0:3], v[84:87], v[68:83]
    buffer_load_dwordx4 v[112:115], v254, s[8:11], s78 offen offset:3072 sc1
    v_mfma_f32_32x32x16_bf16 v[228:243], a[4:7], v[84:87], v[228:243]
    s_waitcnt vmcnt(6)
    v_mfma_f32_32x32x16_bf16 v[68:83], a[8:11], v[88:91], v[68:83]
    s_nop 2
    ds_write_b128 v4, v[52:55] offset:0
    ds_write_b128 v5, v[56:59] offset:0
    ds_write_b128 v6, v[60:63] offset:0
    v_mfma_f32_32x32x16_bf16 v[228:243], a[12:15], v[88:91], v[228:243]
    ds_write_b128 v7, v[64:67] offset:0
    ds_write_b128 v4, v[212:215] offset:128
    ds_write_b128 v5, v[216:219] offset:128
    ds_write_b128 v6, v[220:223] offset:128
    ds_write_b128 v7, v[224:227] offset:128
    s_waitcnt vmcnt(5)
    v_mfma_f32_32x32x16_bf16 v[68:83], a[16:19], v[92:95], v[68:83]
    v_mfma_f32_32x32x16_bf16 v[228:243], a[20:23], v[92:95], v[228:243]
    s_waitcnt vmcnt(4)
    v_mfma_f32_32x32x16_bf16 v[68:83], a[24:27], v[96:99], v[68:83]
    v_mfma_f32_32x32x16_bf16 v[228:243], a[28:31], v[96:99], v[228:243]
    s_waitcnt vmcnt(3)
    v_mfma_f32_32x32x16_bf16 v[68:83], a[32:35], v[100:103], v[68:83]
    v_mfma_f32_32x32x16_bf16 v[228:243], a[36:39], v[100:103], v[228:243]
    s_waitcnt lgkmcnt(0)
    s_barrier
    ds_read_b128 v[116:119], v8 offset:0
    ds_read_b128 v[120:123], v9 offset:0
    ds_read_b128 v[124:127], v8 offset:16384
    s_waitcnt vmcnt(2)
    v_mfma_f32_32x32x16_bf16 v[68:83], a[40:43], v[104:107], v[68:83]
    ds_read_b128 v[128:131], v9 offset:16384
    ds_read_b128 v[132:135], v8 offset:32768
    ds_read_b128 v[136:139], v9 offset:32768
    ds_read_b128 v[140:143], v8 offset:49152
    ds_read_b128 v[144:147], v9 offset:49152
    v_mfma_f32_32x32x16_bf16 v[228:243], a[44:47], v[104:107], v[228:243]
    s_waitcnt vmcnt(1)
    v_mfma_f32_32x32x16_bf16 v[68:83], a[48:51], v[108:111], v[68:83]
    s_waitcnt lgkmcnt(5)
    v_pk_add_f32 v[116:117], v[116:117], v[124:125]
    v_pk_add_f32 v[118:119], v[118:119], v[126:127]
    s_waitcnt lgkmcnt(4)
    v_pk_add_f32 v[120:121], v[120:121], v[128:129]
    v_pk_add_f32 v[122:123], v[122:123], v[130:131]
    v_mfma_f32_32x32x16_bf16 v[228:243], a[52:55], v[108:111], v[228:243]
    s_waitcnt lgkmcnt(1)
    v_pk_add_f32 v[132:133], v[132:133], v[140:141]
    v_pk_add_f32 v[134:135], v[134:135], v[142:143]
    s_waitcnt lgkmcnt(0)
    v_pk_add_f32 v[136:137], v[136:137], v[144:145]
    s_waitcnt vmcnt(0)
    v_mfma_f32_32x32x16_bf16 v[68:83], a[56:59], v[112:115], v[68:83]
    v_pk_add_f32 v[138:139], v[138:139], v[146:147]
    v_pk_add_f32 v[116:117], v[116:117], v[132:133]
    v_pk_add_f32 v[118:119], v[118:119], v[134:135]
    v_pk_add_f32 v[120:121], v[120:121], v[136:137]
    v_pk_add_f32 v[122:123], v[122:123], v[138:139]
    v_mfma_f32_32x32x16_bf16 v[228:243], a[60:63], v[112:115], v[228:243]
    s_nop 5
    ds_write_b128 v4, v[68:71] offset:8192
    v_cvt_pk_bf16_f32 v116, v116, v117
    ds_write_b128 v5, v[72:75] offset:8192
    v_cvt_pk_bf16_f32 v117, v118, v119
    ds_write_b128 v6, v[76:79] offset:8192
    ds_write_b128 v7, v[80:83] offset:8192
    v_cvt_pk_bf16_f32 v118, v120, v121
    ds_write_b128 v4, v[228:231] offset:8320
    v_cvt_pk_bf16_f32 v119, v122, v123
    ds_write_b128 v5, v[232:235] offset:8320
    ds_write_b128 v6, v[236:239] offset:8320
    buffer_store_dwordx4 v[116:119], v16, s[36:39], s82 offen sc1
    ds_write_b128 v7, v[240:243] offset:8320
    s_waitcnt lgkmcnt(0)
    s_barrier
    ds_read_b128 v[148:151], v8 offset:8192
    ds_read_b128 v[152:155], v9 offset:8192
    ds_read_b128 v[156:159], v8 offset:24576
    ds_read_b128 v[160:163], v9 offset:24576
    ds_read_b128 v[164:167], v8 offset:40960
    ds_read_b128 v[168:171], v9 offset:40960
    ds_read_b128 v[172:175], v8 offset:57344
    ds_read_b128 v[176:179], v9 offset:57344
    s_waitcnt lgkmcnt(5)
    v_pk_add_f32 v[148:149], v[148:149], v[156:157]
    v_pk_add_f32 v[150:151], v[150:151], v[158:159]
    s_waitcnt lgkmcnt(4)
    v_pk_add_f32 v[152:153], v[152:153], v[160:161]
    v_pk_add_f32 v[154:155], v[154:155], v[162:163]
    s_waitcnt lgkmcnt(1)
    v_pk_add_f32 v[164:165], v[164:165], v[172:173]
    v_pk_add_f32 v[166:167], v[166:167], v[174:175]
    s_waitcnt lgkmcnt(0)
    v_pk_add_f32 v[168:169], v[168:169], v[176:177]
    v_pk_add_f32 v[170:171], v[170:171], v[178:179]
    v_pk_add_f32 v[148:149], v[148:149], v[164:165]
    v_pk_add_f32 v[150:151], v[150:151], v[166:167]
    v_pk_add_f32 v[152:153], v[152:153], v[168:169]
    v_pk_add_f32 v[154:155], v[154:155], v[170:171]
    v_cvt_pk_bf16_f32 v148, v148, v149
    v_cvt_pk_bf16_f32 v149, v150, v151
    v_cvt_pk_bf16_f32 v150, v152, v153
    v_cvt_pk_bf16_f32 v151, v154, v155
    buffer_store_dwordx4 v[148:151], v17, s[36:39], s82 offen sc1
    s_endpgm
L_nofinal:
    s_waitcnt vmcnt(14)
    v_mul_f32_e64 v35, s62, v28
    v_exp_f32_e64 v35, v35
    s_nop 5
    v_cndmask_b32 v36, v208, v196, s[68:69]
    v_mov_b32_e32 v37, v36
    v_add_f32_e64 v35, 1.0, v35
    s_waitcnt vmcnt(13)
    v_mul_f32_e32 v244, s62, v244
    v_permlane32_swap_b32 v36, v37
    s_waitcnt vmcnt(12)
    v_mul_f32_e64 v245, s62, v245
    v_cndmask_b32 v36, v37, v36, s[68:69]
    v_mul_f32_e64 v35, v35, v36
    v_rcp_f32_e64 v35, v35
    v_exp_f32 v244, -v244
    v_and_b32_e64 v36, v30, v35
    v_and_b32_e64 v37, v32, v35
    v_mul_f32_e64 v196, v196, v36
    v_mul_f32_e64 v197, v197, v35
    v_mul_f32_e64 v198, v198, v35
    v_mul_f32_e64 v199, v199, v35
    v_mul_f32_e64 v200, v200, v35
    v_mul_f32_e64 v201, v201, v35
    v_mul_f32_e64 v202, v202, v35
    v_mul_f32_e64 v203, v203, v35
    v_cvt_pk_bf16_f32 v196, v196, v197
    v_cvt_pk_bf16_f32 v197, v198, v199
    v_cvt_pk_bf16_f32 v198, v200, v201
    v_cvt_pk_bf16_f32 v199, v202, v203
    buffer_store_dwordx4 v[196:199], v1, s[24:27], s75 offen offset:0 sc1
    v_mul_f32_e64 v204, v204, v35
    v_mul_f32_e64 v205, v205, v35
    v_mul_f32_e64 v206, v206, v35
    v_mul_f32_e64 v207, v207, v35
    v_mul_f32_e64 v208, v208, v37
    v_mul_f32_e64 v209, v209, v35
    v_mul_f32_e64 v210, v210, v35
    v_mul_f32_e64 v211, v211, v35
    v_cvt_pk_bf16_f32 v204, v204, v205
    v_cvt_pk_bf16_f32 v205, v206, v207
    v_cvt_pk_bf16_f32 v206, v208, v209
    v_cvt_pk_bf16_f32 v207, v210, v211
    buffer_store_dwordx4 v[204:207], v1, s[24:27], s75 offen offset:1024 sc1
    v_exp_f32 v245, -v245
    v_add_f32_e64 v244, 1.0, v244
    v_add_f32_e64 v245, 1.0, v245
    v_rcp_f32_e64 v244, v244
    v_rcp_f32_e64 v245, v245
    s_waitcnt vmcnt(0)
    s_barrier
    s_cmp_eq_u32 s44, 0
    s_cbranch_scc0 L_nofl21
    v_mov_b32_e64 v33, s57
    s_mov_b32 exec_hi, 0
    buffer_store_dword v33, v50, s[24:27], 0 offen offset:256 sc1
    s_mov_b64 exec, -1
L_nofl21:
L_exit:
    s_endpgm
.section .rodata,"a"
.p2align 6
.amdhsa_kernel gated_mix__sliding_block__glu_gated_glu__prompt_kernel
  .amdhsa_next_free_vgpr 512
  .amdhsa_next_free_sgpr 102
  .amdhsa_accum_offset 256
  .amdhsa_group_segment_fixed_size 0
  .amdhsa_kernarg_size 88
  .amdhsa_user_sgpr_count 2
  .amdhsa_user_sgpr_kernarg_segment_ptr 1
  .amdhsa_system_sgpr_workgroup_id_x 1
.end_amdhsa_kernel
```
